```python
import torch

def _softmax(x, axis=-1):
    return torch.softmax(x, dim=axis)
def _gelu(x):
    return torch.nn.functional.gelu(x, approximate="tanh")
def _silu(x):
    return torch.nn.functional.silu(x)
def _sigmoid(x):
    return torch.sigmoid(x)
def _layernorm(x, axis=-1, eps=1e-5):
    m = x.mean(dim=axis, keepdim=True)
    v = x.var(dim=axis, keepdim=True, unbiased=False)
    return (x - m) / torch.sqrt(v + eps)
def _scatter_add(tgt, idx, src, axis=0):
    return tgt.clone().index_add_(axis, idx, src)
def _segment_sum(src, seg, n):
    out = torch.zeros((n,) + src.shape[1:], dtype=src.dtype)
    return out.index_add_(0, seg, src)
def _pad(x, pw):
    flat = tuple(v for pair in reversed(pw) for v in pair)
    return torch.nn.functional.pad(x, flat)

kernel_name = 'parallel_sum__softmax_full_mha__glu_gated_bilinear__prompt'

def setup_inputs():

    _w = (lambda a: (lambda t: t.to(torch.bfloat16) if t.is_floating_point() else t)(torch.as_tensor(a)))
    def _A_setup():
        B, S, D = 1, 2048, 512
        return {
            "x": _w((lambda *s: torch.randn(*s, dtype=torch.bfloat16) * 0.05)(B, S, D)),
            "wqkv": _w((lambda *s: torch.randn(*s, dtype=torch.bfloat16) * 0.05)(D, 3 * D)),
            "wo": _w((lambda *s: torch.randn(*s, dtype=torch.bfloat16) * 0.05)(D, D)),
        }
    _A_in = _A_setup()

    def _B_setup():
        B, S, D, F = 1, 2048, 512, 1792
        return {
            "x": _w((lambda *s: torch.randn(*s, dtype=torch.bfloat16) * 0.05)(B, S, D)),
            "w_gate": _w((lambda *s: torch.randn(*s, dtype=torch.bfloat16) * 0.4)(D, F) * (D ** -0.5)),
            "w_up": _w((lambda *s: torch.randn(*s, dtype=torch.bfloat16) * 0.4)(D, F) * (D ** -0.5)),
            "w_down": _w((lambda *s: torch.randn(*s, dtype=torch.bfloat16) * 0.4)(F, D) * (F ** -0.5)),
        }
    _B_in = _B_setup()

    return {
        "A_x": _A_in["x"],
        "A_wqkv": _A_in["wqkv"],
        "A_wo": _A_in["wo"],
        "B_x": _B_in["x"],
        "B_w_gate": _B_in["w_gate"],
        "B_w_up": _B_in["w_up"],
        "B_w_down": _B_in["w_down"],
    }

def reference(A_x, A_wqkv, A_wo, B_x, B_w_gate, B_w_up, B_w_down):
    def _A_ref(x, wqkv, wo):
        B, S, D = x.shape
        H = 32; Dh = D // H
        qkv = (lambda x, *d: x.permute(*d))((x @ wqkv).reshape(B, S, 3, H, Dh), 2, 0, 3, 1, 4)
        q, k, v = qkv[0], qkv[1], qkv[2]
        scale = Dh ** -0.5
        scores = torch.einsum("bhqd,bhkd->bhqk", q, k) * scale
        p = _softmax(scores, axis=-1)
        o = torch.einsum("bhqk,bhkd->bhqd", p, v)
        return (lambda x, *d: x.permute(*d))(o, 0, 2, 1, 3).reshape(B, S, D) @ wo

    def _B_ref(x, w_gate, w_up, w_down):
        g = torch.einsum("bsd,df->bsf", x, w_gate)
        u = torch.einsum("bsd,df->bsf", x, w_up)
        h = g * u
        return torch.einsum("bsf,fd->bsd", h, w_down)

    x = A_x
    xn = _layernorm(x, axis=-1)
    return x + _A_ref(xn, A_wqkv, A_wo) + _B_ref(xn, B_w_gate, B_w_up, B_w_down)
```

```asm
; @launch kernel=k1_kernel grid=(256,1,1) block=(256,1,1) lds=163840
; @launch kernel=k2_kernel grid=(256,1,1) block=(768,1,1) lds=163840
.amdgcn_target "amdgcn-amd-amdhsa--gfx950"
.text
.globl k1_kernel
.p2align 8
.type k1_kernel,@function
k1_kernel:
    s_cmp_ge_u32 s2, 256
    s_cbranch_scc1 .Lk1_end
    s_load_dwordx4 s[4:7], s[0:1], 0
    s_load_dwordx4 s[8:11], s[0:1], 32
    s_load_dwordx2 s[12:13], s[0:1], 72
    v_lshlrev_b32 v1, 4, v0
    s_lshr_b32 s62, s2, 3
    s_and_b32 s62, s62, 15
    s_lshl_b32 s62, s62, 12
    v_add_u32 v1, s62, v1
    s_getpc_b64 s[90:91]
.Lk1_pc:
    v_min_u32 v252, .Lk2_end-.Lk1_pc-16, v1
    global_load_dwordx4 v[252:255], v252, s[90:91]
    v_lshrrev_b32 v2, 6, v0
    v_and_b32 v3, 63, v0
    v_readfirstlane_b32 s54, v2
    s_and_b32 s62, s2, 7
    s_lshr_b32 s63, s2, 3
    s_and_b32 s55, s62, 1
    s_lshl_b32 s55, s55, 3
    s_and_b32 s64, s63, 7
    s_add_u32 s55, s55, s64
    s_lshr_b32 s56, s62, 1
    s_mul_i32 s56, s56, 4
    s_lshr_b32 s64, s63, 3
    s_add_u32 s56, s56, s64
    s_lshl_b32 s89, s56, 0
    s_add_u32 s89, s55, s89
    s_and_b32 s89, s89, 7
    s_lshl_b32 s89, s89, 6
    s_lshl_b32 s57, s55, 2
    s_add_u32 s57, s57, s54
    s_lshl_b32 s66, s57, 15
    s_lshl_b32 s58, s54, 10
    s_lshl_b32 s59, s54, 12
    s_add_u32 s59, s59, 32768
    v_lshrrev_b32 v4, 3, v3
    v_and_b32 v5, 7, v3
    v_lshrrev_b32 v6, 1, v4
    v_xor_b32 v7, v5, v6
    v_xor_b32 v8, 4, v7
    v_lshlrev_b32 v9, 10, v4
    v_lshl_add_u32 v7, v7, 4, v9
    v_lshl_add_u32 v8, v8, 4, v9
    s_waitcnt lgkmcnt(0)
    s_mov_b32 s16, s4
    s_mov_b32 s17, s5
    s_mov_b32 s18, 2097152
    s_mov_b32 s19, 131072
    v_mov_b32 v204, v7
    v_mov_b32 v205, v8
    s_add_u32 s60, s89, 0
    s_and_b32 s60, s60, 511
    s_lshl_b32 s60, s60, 1
    s_add_u32 s60, s60, s66
    s_add_u32 m0, s59, 0
    s_add_u32 s62, s60, 0
    buffer_load_dwordx4 v204, s[16:19], s62 offen lds
    s_add_u32 m0, s59, 1024
    s_add_u32 s62, s60, 8192
    buffer_load_dwordx4 v205, s[16:19], s62 offen lds
    s_add_u32 m0, s59, 2048
    s_add_u32 s62, s60, 16384
    buffer_load_dwordx4 v204, s[16:19], s62 offen lds
    s_add_u32 m0, s59, 3072
    s_add_u32 s62, s60, 24576
    buffer_load_dwordx4 v205, s[16:19], s62 offen lds
    s_add_u32 s60, s89, 64
    s_and_b32 s60, s60, 511
    s_lshl_b32 s60, s60, 1
    s_add_u32 s60, s60, s66
    s_add_u32 m0, s59, 16384
    s_add_u32 s62, s60, 0
    buffer_load_dwordx4 v204, s[16:19], s62 offen lds
    s_add_u32 m0, s59, 17408
    s_add_u32 s62, s60, 8192
    buffer_load_dwordx4 v205, s[16:19], s62 offen lds
    s_add_u32 m0, s59, 18432
    s_add_u32 s62, s60, 16384
    buffer_load_dwordx4 v204, s[16:19], s62 offen lds
    s_add_u32 m0, s59, 19456
    s_add_u32 s62, s60, 24576
    buffer_load_dwordx4 v205, s[16:19], s62 offen lds
    s_cmp_ge_u32 s56, 14
    s_cbranch_scc1 .Lk1_typeB_src
    s_lshl_b32 s62, s56, 8
    s_add_u32 s63, s62, 0
    s_add_u32 s20, s8, s63
    s_addc_u32 s21, s9, 0
    s_sub_u32 s22, 1835008, s63
    s_mov_b32 s70, 3584
    s_mov_b32 s75, 0
    s_add_u32 s63, s62, 0
    s_add_u32 s24, s10, s63
    s_addc_u32 s25, s11, 0
    s_sub_u32 s26, 1835008, s63
    s_mov_b32 s71, 3584
    s_mov_b32 s76, 32
    s_add_u32 s63, s62, 128
    s_add_u32 s32, s8, s63
    s_addc_u32 s33, s9, 0
    s_sub_u32 s34, 1835008, s63
    s_mov_b32 s73, 3584
    s_mov_b32 s78, 0
    s_add_u32 s63, s62, 128
    s_add_u32 s36, s10, s63
    s_addc_u32 s37, s11, 0
    s_sub_u32 s38, 1835008, s63
    s_mov_b32 s74, 3584
    s_mov_b32 s79, 32
    s_lshl_b32 s63, s56, 7
    s_add_u32 s28, s6, s63
    s_addc_u32 s29, s7, 0
    s_sub_u32 s30, 1572864, s63
    s_mov_b32 s72, 3072
    s_mov_b32 s77, 0
    s_mov_b32 s85, s56
    s_branch .Lk1_src_done
.Lk1_typeB_src:
    s_sub_u32 s85, s56, 14
    s_mul_i32 s85, s85, 5
    s_add_u32 s85, s85, 14
    s_lshl_b32 s62, s85, 7
    s_add_u32 s63, s62, 0
    s_add_u32 s20, s6, s63
    s_addc_u32 s21, s7, 0
    s_sub_u32 s22, 1572864, s63
    s_mov_b32 s70, 3072
    s_mov_b32 s75, 0
    s_add_u32 s63, s62, 128
    s_add_u32 s24, s6, s63
    s_addc_u32 s25, s7, 0
    s_sub_u32 s26, 1572864, s63
    s_mov_b32 s71, 3072
    s_mov_b32 s76, 0
    s_add_u32 s63, s62, 256
    s_add_u32 s28, s6, s63
    s_addc_u32 s29, s7, 0
    s_sub_u32 s30, 1572864, s63
    s_mov_b32 s72, 3072
    s_mov_b32 s77, 0
    s_add_u32 s63, s62, 384
    s_add_u32 s32, s6, s63
    s_addc_u32 s33, s7, 0
    s_sub_u32 s34, 1572864, s63
    s_mov_b32 s73, 3072
    s_mov_b32 s78, 0
    s_add_u32 s63, s62, 512
    s_add_u32 s36, s6, s63
    s_addc_u32 s37, s7, 0
    s_sub_u32 s38, 1572864, s63
    s_mov_b32 s74, 3072
    s_mov_b32 s79, 0
.Lk1_src_done:
    s_mov_b32 s23, 131072
    s_mov_b32 s27, 131072
    s_mov_b32 s31, 131072
    s_mov_b32 s35, 131072
    s_mov_b32 s39, 131072
    s_add_u32 s60, s89, 128
    s_and_b32 s60, s60, 511
    s_lshl_b32 s60, s60, 1
    s_add_u32 s60, s60, s66
    s_add_u32 m0, s59, 32768
    s_add_u32 s62, s60, 0
    buffer_load_dwordx4 v204, s[16:19], s62 offen lds
    s_add_u32 m0, s59, 33792
    s_add_u32 s62, s60, 8192
    buffer_load_dwordx4 v205, s[16:19], s62 offen lds
    s_add_u32 m0, s59, 34816
    s_add_u32 s62, s60, 16384
    buffer_load_dwordx4 v204, s[16:19], s62 offen lds
    s_add_u32 m0, s59, 35840
    s_add_u32 s62, s60, 24576
    buffer_load_dwordx4 v205, s[16:19], s62 offen lds
    s_add_u32 s60, s89, 192
    s_and_b32 s60, s60, 511
    s_lshl_b32 s60, s60, 1
    s_add_u32 s60, s60, s66
    s_add_u32 m0, s59, 49152
    s_add_u32 s62, s60, 0
    buffer_load_dwordx4 v204, s[16:19], s62 offen lds
    s_add_u32 m0, s59, 50176
    s_add_u32 s62, s60, 8192
    buffer_load_dwordx4 v205, s[16:19], s62 offen lds
    s_add_u32 m0, s59, 51200
    s_add_u32 s62, s60, 16384
    buffer_load_dwordx4 v204, s[16:19], s62 offen lds
    s_add_u32 m0, s59, 52224
    s_add_u32 s62, s60, 24576
    buffer_load_dwordx4 v205, s[16:19], s62 offen lds
    v_and_b32 v6, 1, v6
    v_lshlrev_b32 v6, 2, v6
    v_xor_b32 v6, v5, v6
    v_lshlrev_b32 v6, 4, v6
    s_lshl_b32 s62, s54, 3
    v_add_u32 v9, s62, v4
    v_xor_b32 v1, s75, v6
    v_mad_u32_u24 v20, s70, v9, v1
    v_xor_b32 v1, s76, v6
    v_mad_u32_u24 v21, s71, v9, v1
    v_xor_b32 v1, s77, v6
    v_mad_u32_u24 v22, s72, v9, v1
    v_xor_b32 v1, s78, v6
    v_mad_u32_u24 v23, s73, v9, v1
    v_xor_b32 v1, s79, v6
    v_mad_u32_u24 v24, s74, v9, v1
    v_lshrrev_b32 v1, 5, v3
    v_bfe_u32 v2, v3, 4, 1
    v_bfe_u32 v4, v3, 2, 2
    v_and_b32 v5, 3, v3
    v_and_b32 v9, 31, v3
    v_lshlrev_b32 v5, 3, v1
    v_sub_u32 v9, v9, v5
    v_cmp_eq_u32 vcc, 0, v9
    v_mov_b32 v5, 0x3f80
    s_nop 0
    v_cndmask_b32 v232, 0, v5, vcc
    v_cmp_eq_u32 vcc, 1, v9
    v_mov_b32 v5, 0x3f800000
    s_nop 0
    v_cndmask_b32 v232, v232, v5, vcc
    v_cmp_eq_u32 vcc, 2, v9
    v_mov_b32 v5, 0x3f80
    s_nop 0
    v_cndmask_b32 v233, 0, v5, vcc
    v_cmp_eq_u32 vcc, 3, v9
    v_mov_b32 v5, 0x3f800000
    s_nop 0
    v_cndmask_b32 v233, v233, v5, vcc
    v_cmp_eq_u32 vcc, 4, v9
    v_mov_b32 v5, 0x3f80
    s_nop 0
    v_cndmask_b32 v234, 0, v5, vcc
    v_cmp_eq_u32 vcc, 5, v9
    v_mov_b32 v5, 0x3f800000
    s_nop 0
    v_cndmask_b32 v234, v234, v5, vcc
    v_cmp_eq_u32 vcc, 6, v9
    v_mov_b32 v5, 0x3f80
    s_nop 0
    v_cndmask_b32 v235, 0, v5, vcc
    v_cmp_eq_u32 vcc, 7, v9
    v_mov_b32 v5, 0x3f800000
    s_nop 0
    v_cndmask_b32 v235, v235, v5, vcc
    v_and_b32 v5, 3, v3
    v_lshlrev_b32 v6, 9, v1
    v_lshl_add_u32 v6, v4, 7, v6
    v_lshl_add_u32 v6, v5, 3, v6
    v_and_b32 v5, 2, v4
    v_xor_b32 v5, v5, v2
    s_cmp_ge_u32 s56, 14
    s_cbranch_scc1 .Lk1_typeB_rd
    v_lshl_add_u32 v4, v2, 12, v6
    v_xor_b32 v9, 0, v5
    v_lshl_add_u32 v10, v9, 5, v4
    v_xor_b32 v9, 1, v5
    v_lshl_add_u32 v11, v9, 5, v4
    v_xor_b32 v9, 2, v5
    v_lshl_add_u32 v12, v9, 5, v4
    v_xor_b32 v9, 3, v5
    v_lshl_add_u32 v13, v9, 5, v4
    v_xor_b32 v9, 0, v5
    v_lshl_add_u32 v9, v9, 5, v6
    v_add_u32 v14, 8192, v9
    v_xor_b32 v9, 2, v5
    v_lshl_add_u32 v9, v9, 5, v6
    v_add_u32 v15, 8192, v9
    s_branch .Lk1_rd_done
.Lk1_typeB_rd:
    v_xor_b32 v9, 0, v5
    v_lshl_add_u32 v9, v9, 5, v6
    v_add_u32 v10, 0, v9
    v_xor_b32 v9, 2, v5
    v_lshl_add_u32 v9, v9, 5, v6
    v_add_u32 v11, 0, v9
    v_xor_b32 v9, 0, v5
    v_lshl_add_u32 v9, v9, 5, v6
    v_add_u32 v12, 4096, v9
    v_xor_b32 v9, 2, v5
    v_lshl_add_u32 v9, v9, 5, v6
    v_add_u32 v13, 4096, v9
    v_xor_b32 v9, 0, v5
    v_lshl_add_u32 v9, v9, 5, v6
    v_add_u32 v14, 8192, v9
    v_xor_b32 v9, 2, v5
    v_lshl_add_u32 v9, v9, 5, v6
    v_add_u32 v15, 8192, v9
.Lk1_rd_done:
    s_add_u32 s60, s89, 256
    s_and_b32 s60, s60, 511
    s_lshl_b32 s60, s60, 1
    s_add_u32 s60, s60, s66
    s_add_u32 m0, s59, 65536
    s_add_u32 s62, s60, 0
    buffer_load_dwordx4 v204, s[16:19], s62 offen lds
    s_add_u32 m0, s59, 66560
    s_add_u32 s62, s60, 8192
    buffer_load_dwordx4 v205, s[16:19], s62 offen lds
    s_add_u32 m0, s59, 67584
    s_add_u32 s62, s60, 16384
    buffer_load_dwordx4 v204, s[16:19], s62 offen lds
    s_add_u32 m0, s59, 68608
    s_add_u32 s62, s60, 24576
    buffer_load_dwordx4 v205, s[16:19], s62 offen lds
    s_add_u32 s60, s89, 320
    s_and_b32 s60, s60, 511
    s_lshl_b32 s60, s60, 1
    s_add_u32 s60, s60, s66
    s_add_u32 m0, s59, 81920
    s_add_u32 s62, s60, 0
    buffer_load_dwordx4 v204, s[16:19], s62 offen lds
    s_add_u32 m0, s59, 82944
    s_add_u32 s62, s60, 8192
    buffer_load_dwordx4 v205, s[16:19], s62 offen lds
    s_add_u32 m0, s59, 83968
    s_add_u32 s62, s60, 16384
    buffer_load_dwordx4 v204, s[16:19], s62 offen lds
    s_add_u32 m0, s59, 84992
    s_add_u32 s62, s60, 24576
    buffer_load_dwordx4 v205, s[16:19], s62 offen lds
    s_add_u32 s60, s89, 384
    s_and_b32 s60, s60, 511
    s_lshl_b32 s60, s60, 1
    s_add_u32 s60, s60, s66
    s_add_u32 m0, s59, 98304
    s_add_u32 s62, s60, 0
    buffer_load_dwordx4 v204, s[16:19], s62 offen lds
    s_add_u32 m0, s59, 99328
    s_add_u32 s62, s60, 8192
    buffer_load_dwordx4 v205, s[16:19], s62 offen lds
    s_add_u32 m0, s59, 100352
    s_add_u32 s62, s60, 16384
    buffer_load_dwordx4 v204, s[16:19], s62 offen lds
    s_add_u32 m0, s59, 101376
    s_add_u32 s62, s60, 24576
    buffer_load_dwordx4 v205, s[16:19], s62 offen lds
    s_add_u32 s60, s89, 448
    s_and_b32 s60, s60, 511
    s_lshl_b32 s60, s60, 1
    s_add_u32 s60, s60, s66
    s_add_u32 m0, s59, 114688
    s_add_u32 s62, s60, 0
    buffer_load_dwordx4 v204, s[16:19], s62 offen lds
    s_add_u32 m0, s59, 115712
    s_add_u32 s62, s60, 8192
    buffer_load_dwordx4 v205, s[16:19], s62 offen lds
    s_add_u32 m0, s59, 116736
    s_add_u32 s62, s60, 16384
    buffer_load_dwordx4 v204, s[16:19], s62 offen lds
    s_add_u32 m0, s59, 117760
    s_add_u32 s62, s60, 24576
    buffer_load_dwordx4 v205, s[16:19], s62 offen lds
    v_lshlrev_b32 v30, 4, v3
    v_and_b32 v9, 31, v3
    v_lshlrev_b32 v9, 5, v9
    v_lshl_add_u32 v31, v1, 4, v9
    v_and_b32 v9, 31, v3
    v_bfe_u32 v2, v3, 1, 3
    v_xor_b32 v2, v2, v1
    v_lshlrev_b32 v9, 7, v9
    v_add_u32 v9, s59, v9
    v_xor_b32 v4, 0, v2
    v_lshl_add_u32 v200, v4, 4, v9
    v_xor_b32 v4, 2, v2
    v_lshl_add_u32 v201, v4, 4, v9
    v_xor_b32 v4, 4, v2
    v_lshl_add_u32 v202, v4, 4, v9
    v_xor_b32 v4, 6, v2
    v_lshl_add_u32 v203, v4, 4, v9
    s_mov_b32 s67, 0x3f803f80
    s_mov_b32 s68, 0xffff0000
    s_mov_b32 s87, 0x00003f80
    s_mov_b32 s88, 0x3f800000
    v_mov_b32 v160, 0
    v_mov_b32 v161, 0
    v_mov_b32 v162, 0
    v_mov_b32 v163, 0
    v_mov_b32 v164, 0
    v_mov_b32 v165, 0
    v_mov_b32 v166, 0
    v_mov_b32 v167, 0
    v_mov_b32 v28, 0
    v_mov_b32 v29, 0
    s_mov_b32 s40, s12
    s_mov_b32 s41, s13
    s_mov_b32 s42, 268435456
    s_mov_b32 s43, 131072
    s_lshl_b32 s83, s57, 10
    s_mul_i32 s69, s57, 112
    s_lshl_b32 s62, s56, 3
    s_add_u32 s69, s69, s62
    s_lshl_b32 s69, s69, 10
    s_add_u32 s69, s69, 6291456
    s_waitcnt vmcnt(28)
    ds_read_b128 v[32:35], v200 offset:0
    ds_read_b128 v[36:39], v201 offset:0
    ds_read_b128 v[40:43], v202 offset:0
    ds_read_b128 v[44:47], v203 offset:0
    s_waitcnt vmcnt(24)
    ds_read_b128 v[48:51], v200 offset:16384
    ds_read_b128 v[52:55], v201 offset:16384
    ds_read_b128 v[56:59], v202 offset:16384
    ds_read_b128 v[60:63], v203 offset:16384
    s_waitcnt lgkmcnt(4)
    v_dot2c_f32_bf16 v160, s67, v32
    v_dot2c_f32_bf16 v164, v32, v32
    v_dot2c_f32_bf16 v161, s67, v33
    v_dot2c_f32_bf16 v165, v33, v33
    v_dot2c_f32_bf16 v162, s67, v34
    v_dot2c_f32_bf16 v166, v34, v34
    v_dot2c_f32_bf16 v163, s67, v35
    v_dot2c_f32_bf16 v167, v35, v35
    s_add_u32 s61, s89, 0
    s_and_b32 s61, s61, 511
    s_add_u32 m0, s58, 0
    s_mul_i32 s44, s61, s70
    buffer_load_dwordx4 v20, s[20:23], s44 offen lds
    v_dot2c_f32_bf16 v160, s67, v36
    v_dot2c_f32_bf16 v164, v36, v36
    v_dot2c_f32_bf16 v161, s67, v37
    v_dot2c_f32_bf16 v165, v37, v37
    v_dot2c_f32_bf16 v162, s67, v38
    v_dot2c_f32_bf16 v166, v38, v38
    v_dot2c_f32_bf16 v163, s67, v39
    v_dot2c_f32_bf16 v167, v39, v39
    s_add_u32 m0, s58, 4096
    s_mul_i32 s45, s61, s71
    buffer_load_dwordx4 v21, s[24:27], s45 offen lds
    v_dot2c_f32_bf16 v160, s67, v40
    v_dot2c_f32_bf16 v164, v40, v40
    v_dot2c_f32_bf16 v161, s67, v41
    v_dot2c_f32_bf16 v165, v41, v41
    v_dot2c_f32_bf16 v162, s67, v42
    v_dot2c_f32_bf16 v166, v42, v42
    v_dot2c_f32_bf16 v163, s67, v43
    v_dot2c_f32_bf16 v167, v43, v43
    s_add_u32 m0, s58, 8192
    s_mul_i32 s46, s61, s72
    buffer_load_dwordx4 v22, s[28:31], s46 offen lds
    v_dot2c_f32_bf16 v160, s67, v44
    v_dot2c_f32_bf16 v164, v44, v44
    v_dot2c_f32_bf16 v161, s67, v45
    v_dot2c_f32_bf16 v165, v45, v45
    v_dot2c_f32_bf16 v162, s67, v46
    v_dot2c_f32_bf16 v166, v46, v46
    v_dot2c_f32_bf16 v163, s67, v47
    v_dot2c_f32_bf16 v167, v47, v47
    s_add_u32 s61, s89, 32
    s_and_b32 s61, s61, 511
    s_add_u32 m0, s58, 12288
    s_mul_i32 s44, s61, s70
    buffer_load_dwordx4 v20, s[20:23], s44 offen lds
    s_add_u32 m0, s58, 16384
    s_mul_i32 s45, s61, s71
    buffer_load_dwordx4 v21, s[24:27], s45 offen lds
    s_add_u32 m0, s58, 20480
    s_mul_i32 s46, s61, s72
    buffer_load_dwordx4 v22, s[28:31], s46 offen lds
    s_waitcnt vmcnt(26)
    ds_read_b128 v[64:67], v200 offset:32768
    ds_read_b128 v[68:71], v201 offset:32768
    ds_read_b128 v[72:75], v202 offset:32768
    ds_read_b128 v[76:79], v203 offset:32768
    s_waitcnt lgkmcnt(4)
    v_dot2c_f32_bf16 v160, s67, v48
    v_dot2c_f32_bf16 v164, v48, v48
    v_dot2c_f32_bf16 v161, s67, v49
    v_dot2c_f32_bf16 v165, v49, v49
    v_dot2c_f32_bf16 v162, s67, v50
    v_dot2c_f32_bf16 v166, v50, v50
    v_dot2c_f32_bf16 v163, s67, v51
    v_dot2c_f32_bf16 v167, v51, v51
    v_dot2c_f32_bf16 v160, s67, v52
    v_dot2c_f32_bf16 v164, v52, v52
    v_dot2c_f32_bf16 v161, s67, v53
    v_dot2c_f32_bf16 v165, v53, v53
    v_dot2c_f32_bf16 v162, s67, v54
    v_dot2c_f32_bf16 v166, v54, v54
    v_dot2c_f32_bf16 v163, s67, v55
    v_dot2c_f32_bf16 v167, v55, v55
    v_dot2c_f32_bf16 v160, s67, v56
    v_dot2c_f32_bf16 v164, v56, v56
    v_dot2c_f32_bf16 v161, s67, v57
    v_dot2c_f32_bf16 v165, v57, v57
    v_dot2c_f32_bf16 v162, s67, v58
    v_dot2c_f32_bf16 v166, v58, v58
    v_dot2c_f32_bf16 v163, s67, v59
    v_dot2c_f32_bf16 v167, v59, v59
    v_dot2c_f32_bf16 v160, s67, v60
    v_dot2c_f32_bf16 v164, v60, v60
    v_dot2c_f32_bf16 v161, s67, v61
    v_dot2c_f32_bf16 v165, v61, v61
    v_dot2c_f32_bf16 v162, s67, v62
    v_dot2c_f32_bf16 v166, v62, v62
    v_dot2c_f32_bf16 v163, s67, v63
    v_dot2c_f32_bf16 v167, v63, v63
    s_waitcnt vmcnt(22)
    ds_read_b128 v[80:83], v200 offset:49152
    ds_read_b128 v[84:87], v201 offset:49152
    ds_read_b128 v[88:91], v202 offset:49152
    ds_read_b128 v[92:95], v203 offset:49152
    s_waitcnt lgkmcnt(4)
    v_dot2c_f32_bf16 v160, s67, v64
    v_dot2c_f32_bf16 v164, v64, v64
    v_dot2c_f32_bf16 v161, s67, v65
    v_dot2c_f32_bf16 v165, v65, v65
    v_dot2c_f32_bf16 v162, s67, v66
    v_dot2c_f32_bf16 v166, v66, v66
    v_dot2c_f32_bf16 v163, s67, v67
    v_dot2c_f32_bf16 v167, v67, v67
    v_dot2c_f32_bf16 v160, s67, v68
    v_dot2c_f32_bf16 v164, v68, v68
    v_dot2c_f32_bf16 v161, s67, v69
    v_dot2c_f32_bf16 v165, v69, v69
    v_dot2c_f32_bf16 v162, s67, v70
    v_dot2c_f32_bf16 v166, v70, v70
    v_dot2c_f32_bf16 v163, s67, v71
    v_dot2c_f32_bf16 v167, v71, v71
    v_dot2c_f32_bf16 v160, s67, v72
    v_dot2c_f32_bf16 v164, v72, v72
    v_dot2c_f32_bf16 v161, s67, v73
    v_dot2c_f32_bf16 v165, v73, v73
    v_dot2c_f32_bf16 v162, s67, v74
    v_dot2c_f32_bf16 v166, v74, v74
    v_dot2c_f32_bf16 v163, s67, v75
    v_dot2c_f32_bf16 v167, v75, v75
    v_dot2c_f32_bf16 v160, s67, v76
    v_dot2c_f32_bf16 v164, v76, v76
    v_dot2c_f32_bf16 v161, s67, v77
    v_dot2c_f32_bf16 v165, v77, v77
    v_dot2c_f32_bf16 v162, s67, v78
    v_dot2c_f32_bf16 v166, v78, v78
    v_dot2c_f32_bf16 v163, s67, v79
    v_dot2c_f32_bf16 v167, v79, v79
    s_waitcnt vmcnt(18)
    v_add_u32 v200, 0x10000, v200
    v_add_u32 v201, 0x10000, v201
    v_add_u32 v202, 0x10000, v202
    v_add_u32 v203, 0x10000, v203
    ds_read_b128 v[96:99], v200 offset:0
    ds_read_b128 v[100:103], v201 offset:0
    ds_read_b128 v[104:107], v202 offset:0
    ds_read_b128 v[108:111], v203 offset:0
    s_waitcnt lgkmcnt(4)
    v_dot2c_f32_bf16 v160, s67, v80
    v_dot2c_f32_bf16 v164, v80, v80
    v_dot2c_f32_bf16 v161, s67, v81
    v_dot2c_f32_bf16 v165, v81, v81
    v_dot2c_f32_bf16 v162, s67, v82
    v_dot2c_f32_bf16 v166, v82, v82
    v_dot2c_f32_bf16 v163, s67, v83
    v_dot2c_f32_bf16 v167, v83, v83
    v_dot2c_f32_bf16 v160, s67, v84
    v_dot2c_f32_bf16 v164, v84, v84
    v_dot2c_f32_bf16 v161, s67, v85
    v_dot2c_f32_bf16 v165, v85, v85
    v_dot2c_f32_bf16 v162, s67, v86
    v_dot2c_f32_bf16 v166, v86, v86
    v_dot2c_f32_bf16 v163, s67, v87
    v_dot2c_f32_bf16 v167, v87, v87
    v_dot2c_f32_bf16 v160, s67, v88
    v_dot2c_f32_bf16 v164, v88, v88
    v_dot2c_f32_bf16 v161, s67, v89
    v_dot2c_f32_bf16 v165, v89, v89
    v_dot2c_f32_bf16 v162, s67, v90
    v_dot2c_f32_bf16 v166, v90, v90
    v_dot2c_f32_bf16 v163, s67, v91
    v_dot2c_f32_bf16 v167, v91, v91
    v_dot2c_f32_bf16 v160, s67, v92
    v_dot2c_f32_bf16 v164, v92, v92
    v_dot2c_f32_bf16 v161, s67, v93
    v_dot2c_f32_bf16 v165, v93, v93
    v_dot2c_f32_bf16 v162, s67, v94
    v_dot2c_f32_bf16 v166, v94, v94
    v_dot2c_f32_bf16 v163, s67, v95
    v_dot2c_f32_bf16 v167, v95, v95
    s_waitcnt vmcnt(14)
    ds_read_b128 v[112:115], v200 offset:16384
    ds_read_b128 v[116:119], v201 offset:16384
    ds_read_b128 v[120:123], v202 offset:16384
    ds_read_b128 v[124:127], v203 offset:16384
    s_waitcnt lgkmcnt(4)
    v_dot2c_f32_bf16 v160, s67, v96
    v_dot2c_f32_bf16 v164, v96, v96
    v_dot2c_f32_bf16 v161, s67, v97
    v_dot2c_f32_bf16 v165, v97, v97
    v_dot2c_f32_bf16 v162, s67, v98
    v_dot2c_f32_bf16 v166, v98, v98
    v_dot2c_f32_bf16 v163, s67, v99
    v_dot2c_f32_bf16 v167, v99, v99
    v_dot2c_f32_bf16 v160, s67, v100
    v_dot2c_f32_bf16 v164, v100, v100
    v_dot2c_f32_bf16 v161, s67, v101
    v_dot2c_f32_bf16 v165, v101, v101
    v_dot2c_f32_bf16 v162, s67, v102
    v_dot2c_f32_bf16 v166, v102, v102
    v_dot2c_f32_bf16 v163, s67, v103
    v_dot2c_f32_bf16 v167, v103, v103
    v_dot2c_f32_bf16 v160, s67, v104
    v_dot2c_f32_bf16 v164, v104, v104
    v_dot2c_f32_bf16 v161, s67, v105
    v_dot2c_f32_bf16 v165, v105, v105
    v_dot2c_f32_bf16 v162, s67, v106
    v_dot2c_f32_bf16 v166, v106, v106
    v_dot2c_f32_bf16 v163, s67, v107
    v_dot2c_f32_bf16 v167, v107, v107
    v_dot2c_f32_bf16 v160, s67, v108
    v_dot2c_f32_bf16 v164, v108, v108
    v_dot2c_f32_bf16 v161, s67, v109
    v_dot2c_f32_bf16 v165, v109, v109
    v_dot2c_f32_bf16 v162, s67, v110
    v_dot2c_f32_bf16 v166, v110, v110
    v_dot2c_f32_bf16 v163, s67, v111
    v_dot2c_f32_bf16 v167, v111, v111
    s_waitcnt vmcnt(10)
    ds_read_b128 v[128:131], v200 offset:32768
    ds_read_b128 v[132:135], v201 offset:32768
    ds_read_b128 v[136:139], v202 offset:32768
    ds_read_b128 v[140:143], v203 offset:32768
    s_waitcnt lgkmcnt(4)
    v_dot2c_f32_bf16 v160, s67, v112
    v_dot2c_f32_bf16 v164, v112, v112
    v_dot2c_f32_bf16 v161, s67, v113
    v_dot2c_f32_bf16 v165, v113, v113
    v_dot2c_f32_bf16 v162, s67, v114
    v_dot2c_f32_bf16 v166, v114, v114
    v_dot2c_f32_bf16 v163, s67, v115
    v_dot2c_f32_bf16 v167, v115, v115
    v_dot2c_f32_bf16 v160, s67, v116
    v_dot2c_f32_bf16 v164, v116, v116
    v_dot2c_f32_bf16 v161, s67, v117
    v_dot2c_f32_bf16 v165, v117, v117
    v_dot2c_f32_bf16 v162, s67, v118
    v_dot2c_f32_bf16 v166, v118, v118
    v_dot2c_f32_bf16 v163, s67, v119
    v_dot2c_f32_bf16 v167, v119, v119
    v_dot2c_f32_bf16 v160, s67, v120
    v_dot2c_f32_bf16 v164, v120, v120
    v_dot2c_f32_bf16 v161, s67, v121
    v_dot2c_f32_bf16 v165, v121, v121
    v_dot2c_f32_bf16 v162, s67, v122
    v_dot2c_f32_bf16 v166, v122, v122
    v_dot2c_f32_bf16 v163, s67, v123
    v_dot2c_f32_bf16 v167, v123, v123
    v_dot2c_f32_bf16 v160, s67, v124
    v_dot2c_f32_bf16 v164, v124, v124
    v_dot2c_f32_bf16 v161, s67, v125
    v_dot2c_f32_bf16 v165, v125, v125
    v_dot2c_f32_bf16 v162, s67, v126
    v_dot2c_f32_bf16 v166, v126, v126
    v_dot2c_f32_bf16 v163, s67, v127
    v_dot2c_f32_bf16 v167, v127, v127
    s_waitcnt vmcnt(6)
    ds_read_b128 v[144:147], v200 offset:49152
    ds_read_b128 v[148:151], v201 offset:49152
    ds_read_b128 v[152:155], v202 offset:49152
    ds_read_b128 v[156:159], v203 offset:49152
    s_waitcnt lgkmcnt(4)
    v_dot2c_f32_bf16 v160, s67, v128
    v_dot2c_f32_bf16 v164, v128, v128
    v_dot2c_f32_bf16 v161, s67, v129
    v_dot2c_f32_bf16 v165, v129, v129
    v_dot2c_f32_bf16 v162, s67, v130
    v_dot2c_f32_bf16 v166, v130, v130
    v_dot2c_f32_bf16 v163, s67, v131
    v_dot2c_f32_bf16 v167, v131, v131
    v_dot2c_f32_bf16 v160, s67, v132
    v_dot2c_f32_bf16 v164, v132, v132
    v_dot2c_f32_bf16 v161, s67, v133
    v_dot2c_f32_bf16 v165, v133, v133
    v_dot2c_f32_bf16 v162, s67, v134
    v_dot2c_f32_bf16 v166, v134, v134
    v_dot2c_f32_bf16 v163, s67, v135
    v_dot2c_f32_bf16 v167, v135, v135
    v_dot2c_f32_bf16 v160, s67, v136
    v_dot2c_f32_bf16 v164, v136, v136
    v_dot2c_f32_bf16 v161, s67, v137
    v_dot2c_f32_bf16 v165, v137, v137
    v_dot2c_f32_bf16 v162, s67, v138
    v_dot2c_f32_bf16 v166, v138, v138
    v_dot2c_f32_bf16 v163, s67, v139
    v_dot2c_f32_bf16 v167, v139, v139
    v_dot2c_f32_bf16 v160, s67, v140
    v_dot2c_f32_bf16 v164, v140, v140
    v_dot2c_f32_bf16 v161, s67, v141
    v_dot2c_f32_bf16 v165, v141, v141
    v_dot2c_f32_bf16 v162, s67, v142
    v_dot2c_f32_bf16 v166, v142, v142
    v_dot2c_f32_bf16 v163, s67, v143
    v_dot2c_f32_bf16 v167, v143, v143
    s_waitcnt lgkmcnt(0)
    s_barrier
    v_dot2c_f32_bf16 v160, s67, v144
    v_dot2c_f32_bf16 v164, v144, v144
    v_dot2c_f32_bf16 v161, s67, v145
    v_dot2c_f32_bf16 v165, v145, v145
    v_dot2c_f32_bf16 v162, s67, v146
    v_dot2c_f32_bf16 v166, v146, v146
    v_dot2c_f32_bf16 v163, s67, v147
    v_dot2c_f32_bf16 v167, v147, v147
    v_dot2c_f32_bf16 v160, s67, v148
    v_dot2c_f32_bf16 v164, v148, v148
    v_dot2c_f32_bf16 v161, s67, v149
    v_dot2c_f32_bf16 v165, v149, v149
    v_dot2c_f32_bf16 v162, s67, v150
    v_dot2c_f32_bf16 v166, v150, v150
    v_dot2c_f32_bf16 v163, s67, v151
    v_dot2c_f32_bf16 v167, v151, v151
    v_dot2c_f32_bf16 v160, s67, v152
    v_dot2c_f32_bf16 v164, v152, v152
    v_dot2c_f32_bf16 v161, s67, v153
    v_dot2c_f32_bf16 v165, v153, v153
    v_dot2c_f32_bf16 v162, s67, v154
    v_dot2c_f32_bf16 v166, v154, v154
    v_dot2c_f32_bf16 v163, s67, v155
    v_dot2c_f32_bf16 v167, v155, v155
    v_dot2c_f32_bf16 v160, s67, v156
    v_dot2c_f32_bf16 v164, v156, v156
    v_dot2c_f32_bf16 v161, s67, v157
    v_dot2c_f32_bf16 v165, v157, v157
    v_dot2c_f32_bf16 v162, s67, v158
    v_dot2c_f32_bf16 v166, v158, v158
    v_dot2c_f32_bf16 v163, s67, v159
    v_dot2c_f32_bf16 v167, v159, v159
    v_add_f32 v160, v160, v161
    s_nop 0
    v_add_f32 v162, v162, v163
    v_add_f32 v164, v164, v165
    v_add_f32 v166, v166, v167
    v_add_f32 v160, v160, v162
    v_add_f32 v164, v164, v166
    v_mov_b32 v161, v160
    v_mov_b32 v165, v164
    s_nop 0
    v_permlane32_swap_b32 v160, v161
    v_permlane32_swap_b32 v164, v165
    v_add_f32 v160, v160, v161
    v_add_f32 v164, v164, v165
    v_mul_f32 v16, 0xbb000000, v160
    v_mul_f32 v164, 0x3b000000, v164
    v_fma_f32 v164, -v16, v16, v164
    v_max_f32 v164, 0, v164
    v_add_f32 v164, 0x3727c5ac, v164
    v_rsq_f32 v25, v164
    s_nop 0
    v_mul_f32 v26, v25, v25
    v_mov_b32 v240, v16
    v_mov_b32 v241, v16
    v_mov_b32 v242, v16
    v_mov_b32 v243, v16
    v_mov_b32 v244, v16
    v_mov_b32 v245, v16
    v_mov_b32 v246, v16
    v_mov_b32 v247, v16
    v_mov_b32 v248, 0
    v_mov_b32 v249, 0
    v_mov_b32 v250, 0
    v_mov_b32 v251, 0
    v_mov_b32 v252, 0
    v_mov_b32 v253, 0
    v_mov_b32 v254, 0
    v_mov_b32 v255, 0
    s_nop 1
    v_mfma_f32_32x32x16_bf16 v[168:183], v[232:235], v[32:35], v[240:255]
    s_add_u32 s61, s89, 64
    s_and_b32 s61, s61, 511
    s_add_u32 m0, s58, 24576
    s_mul_i32 s44, s61, s70
    buffer_load_dwordx4 v20, s[20:23], s44 offen lds
    v_mfma_f32_32x32x16_bf16 v[184:199], v[232:235], v[36:39], v[240:255]
    s_add_u32 m0, s58, 28672
    s_mul_i32 s45, s61, s71
    buffer_load_dwordx4 v21, s[24:27], s45 offen lds
    v_mfma_f32_32x32x16_bf16 v[200:215], v[232:235], v[40:43], v[240:255]
    s_nop 1
    v_cvt_pk_bf16_f32 v32, v168, v169
    v_cvt_pk_bf16_f32 v33, v170, v171
    v_cvt_pk_bf16_f32 v34, v172, v173
    v_cvt_pk_bf16_f32 v35, v174, v175
    v_mfma_f32_32x32x16_bf16 v[216:231], v[232:235], v[44:47], v[240:255]
    s_nop 0
    v_cvt_pk_bf16_f32 v36, v184, v185
    v_cvt_pk_bf16_f32 v37, v186, v187
    v_cvt_pk_bf16_f32 v38, v188, v189
    v_cvt_pk_bf16_f32 v39, v190, v191
    s_add_u32 m0, s58, 32768
    s_mul_i32 s46, s61, s72
    buffer_load_dwordx4 v22, s[28:31], s46 offen lds
    v_mfma_f32_32x32x16_bf16 v[168:183], v[232:235], v[48:51], v[240:255]
    v_cvt_pk_bf16_f32 v40, v200, v201
    v_cvt_pk_bf16_f32 v41, v202, v203
    v_cvt_pk_bf16_f32 v42, v204, v205
    v_cvt_pk_bf16_f32 v43, v206, v207
    s_add_u32 s61, s89, 96
    s_and_b32 s61, s61, 511
    s_add_u32 m0, s58, 36864
    s_mul_i32 s44, s61, s70
    buffer_load_dwordx4 v20, s[20:23], s44 offen lds
    v_mfma_f32_32x32x16_bf16 v[184:199], v[232:235], v[52:55], v[240:255]
    v_cvt_pk_bf16_f32 v44, v216, v217
    v_cvt_pk_bf16_f32 v45, v218, v219
    v_cvt_pk_bf16_f32 v46, v220, v221
    v_cvt_pk_bf16_f32 v47, v222, v223
    v_mfma_f32_32x32x16_bf16 v[200:215], v[232:235], v[56:59], v[240:255]
    v_cvt_pk_bf16_f32 v48, v168, v169
    v_cvt_pk_bf16_f32 v49, v170, v171
    v_cvt_pk_bf16_f32 v50, v172, v173
    v_cvt_pk_bf16_f32 v51, v174, v175
    s_add_u32 m0, s58, 40960
    s_mul_i32 s45, s61, s71
    buffer_load_dwordx4 v21, s[24:27], s45 offen lds
    v_mfma_f32_32x32x16_bf16 v[216:231], v[232:235], v[60:63], v[240:255]
    v_cvt_pk_bf16_f32 v52, v184, v185
    v_cvt_pk_bf16_f32 v53, v186, v187
    v_cvt_pk_bf16_f32 v54, v188, v189
    v_cvt_pk_bf16_f32 v55, v190, v191
    s_add_u32 m0, s58, 45056
    s_mul_i32 s46, s61, s72
    buffer_load_dwordx4 v22, s[28:31], s46 offen lds
    v_mfma_f32_32x32x16_bf16 v[168:183], v[232:235], v[64:67], v[240:255]
    v_cvt_pk_bf16_f32 v56, v200, v201
    v_cvt_pk_bf16_f32 v57, v202, v203
    v_cvt_pk_bf16_f32 v58, v204, v205
    v_cvt_pk_bf16_f32 v59, v206, v207
    v_mfma_f32_32x32x16_bf16 v[184:199], v[232:235], v[68:71], v[240:255]
    v_cvt_pk_bf16_f32 v60, v216, v217
    v_cvt_pk_bf16_f32 v61, v218, v219
    v_cvt_pk_bf16_f32 v62, v220, v221
    v_cvt_pk_bf16_f32 v63, v222, v223
    s_add_u32 s61, s89, 128
    s_and_b32 s61, s61, 511
    s_add_u32 m0, s58, 49152
    s_mul_i32 s44, s61, s70
    buffer_load_dwordx4 v20, s[20:23], s44 offen lds
    v_mfma_f32_32x32x16_bf16 v[200:215], v[232:235], v[72:75], v[240:255]
    v_cvt_pk_bf16_f32 v64, v168, v169
    v_cvt_pk_bf16_f32 v65, v170, v171
    v_cvt_pk_bf16_f32 v66, v172, v173
    v_cvt_pk_bf16_f32 v67, v174, v175
    s_add_u32 m0, s58, 53248
    s_mul_i32 s45, s61, s71
    buffer_load_dwordx4 v21, s[24:27], s45 offen lds
    v_mfma_f32_32x32x16_bf16 v[216:231], v[232:235], v[76:79], v[240:255]
    v_cvt_pk_bf16_f32 v68, v184, v185
    v_cvt_pk_bf16_f32 v69, v186, v187
    v_cvt_pk_bf16_f32 v70, v188, v189
    v_cvt_pk_bf16_f32 v71, v190, v191
    v_mfma_f32_32x32x16_bf16 v[168:183], v[232:235], v[80:83], v[240:255]
    v_cvt_pk_bf16_f32 v72, v200, v201
    v_cvt_pk_bf16_f32 v73, v202, v203
    v_cvt_pk_bf16_f32 v74, v204, v205
    v_cvt_pk_bf16_f32 v75, v206, v207
    s_add_u32 m0, s58, 57344
    s_mul_i32 s46, s61, s72
    buffer_load_dwordx4 v22, s[28:31], s46 offen lds
    v_mfma_f32_32x32x16_bf16 v[184:199], v[232:235], v[84:87], v[240:255]
    v_cvt_pk_bf16_f32 v76, v216, v217
    v_cvt_pk_bf16_f32 v77, v218, v219
    v_cvt_pk_bf16_f32 v78, v220, v221
    v_cvt_pk_bf16_f32 v79, v222, v223
    s_add_u32 s61, s89, 160
    s_and_b32 s61, s61, 511
    s_add_u32 m0, s58, 61440
    s_mul_i32 s44, s61, s70
    buffer_load_dwordx4 v20, s[20:23], s44 offen lds
    v_mfma_f32_32x32x16_bf16 v[200:215], v[232:235], v[88:91], v[240:255]
    v_cvt_pk_bf16_f32 v80, v168, v169
    v_cvt_pk_bf16_f32 v81, v170, v171
    v_cvt_pk_bf16_f32 v82, v172, v173
    v_cvt_pk_bf16_f32 v83, v174, v175
    v_mfma_f32_32x32x16_bf16 v[216:231], v[232:235], v[92:95], v[240:255]
    v_cvt_pk_bf16_f32 v84, v184, v185
    v_cvt_pk_bf16_f32 v85, v186, v187
    v_cvt_pk_bf16_f32 v86, v188, v189
    v_cvt_pk_bf16_f32 v87, v190, v191
    s_add_u32 m0, s58, 65536
    s_mul_i32 s45, s61, s71
    buffer_load_dwordx4 v21, s[24:27], s45 offen lds
    v_mfma_f32_32x32x16_bf16 v[168:183], v[232:235], v[96:99], v[240:255]
    v_cvt_pk_bf16_f32 v88, v200, v201
    v_cvt_pk_bf16_f32 v89, v202, v203
    v_cvt_pk_bf16_f32 v90, v204, v205
    v_cvt_pk_bf16_f32 v91, v206, v207
    s_add_u32 m0, s58, 69632
    s_mul_i32 s46, s61, s72
    buffer_load_dwordx4 v22, s[28:31], s46 offen lds
    v_mfma_f32_32x32x16_bf16 v[184:199], v[232:235], v[100:103], v[240:255]
    v_cvt_pk_bf16_f32 v92, v216, v217
    v_cvt_pk_bf16_f32 v93, v218, v219
    v_cvt_pk_bf16_f32 v94, v220, v221
    v_cvt_pk_bf16_f32 v95, v222, v223
    v_mfma_f32_32x32x16_bf16 v[200:215], v[232:235], v[104:107], v[240:255]
    v_cvt_pk_bf16_f32 v96, v168, v169
    v_cvt_pk_bf16_f32 v97, v170, v171
    v_cvt_pk_bf16_f32 v98, v172, v173
    v_cvt_pk_bf16_f32 v99, v174, v175
    s_add_u32 s61, s89, 192
    s_and_b32 s61, s61, 511
    s_add_u32 m0, s58, 73728
    s_mul_i32 s44, s61, s70
    buffer_load_dwordx4 v20, s[20:23], s44 offen lds
    v_mfma_f32_32x32x16_bf16 v[216:231], v[232:235], v[108:111], v[240:255]
    v_cvt_pk_bf16_f32 v100, v184, v185
    v_cvt_pk_bf16_f32 v101, v186, v187
    v_cvt_pk_bf16_f32 v102, v188, v189
    v_cvt_pk_bf16_f32 v103, v190, v191
    s_add_u32 m0, s58, 77824
    s_mul_i32 s45, s61, s71
    buffer_load_dwordx4 v21, s[24:27], s45 offen lds
    v_mfma_f32_32x32x16_bf16 v[168:183], v[232:235], v[112:115], v[240:255]
    v_cvt_pk_bf16_f32 v104, v200, v201
    v_cvt_pk_bf16_f32 v105, v202, v203
    v_cvt_pk_bf16_f32 v106, v204, v205
    v_cvt_pk_bf16_f32 v107, v206, v207
    v_mfma_f32_32x32x16_bf16 v[184:199], v[232:235], v[116:119], v[240:255]
    v_cvt_pk_bf16_f32 v108, v216, v217
    v_cvt_pk_bf16_f32 v109, v218, v219
    v_cvt_pk_bf16_f32 v110, v220, v221
    v_cvt_pk_bf16_f32 v111, v222, v223
    s_add_u32 m0, s58, 81920
    s_mul_i32 s46, s61, s72
    buffer_load_dwordx4 v22, s[28:31], s46 offen lds
    v_mfma_f32_32x32x16_bf16 v[200:215], v[232:235], v[120:123], v[240:255]
    v_cvt_pk_bf16_f32 v112, v168, v169
    v_cvt_pk_bf16_f32 v113, v170, v171
    v_cvt_pk_bf16_f32 v114, v172, v173
    v_cvt_pk_bf16_f32 v115, v174, v175
    s_add_u32 s61, s89, 224
    s_and_b32 s61, s61, 511
    s_add_u32 m0, s58, 86016
    s_mul_i32 s44, s61, s70
    buffer_load_dwordx4 v20, s[20:23], s44 offen lds
    v_mfma_f32_32x32x16_bf16 v[216:231], v[232:235], v[124:127], v[240:255]
    v_cvt_pk_bf16_f32 v116, v184, v185
    v_cvt_pk_bf16_f32 v117, v186, v187
    v_cvt_pk_bf16_f32 v118, v188, v189
    v_cvt_pk_bf16_f32 v119, v190, v191
    v_mfma_f32_32x32x16_bf16 v[168:183], v[232:235], v[128:131], v[240:255]
    v_cvt_pk_bf16_f32 v120, v200, v201
    v_cvt_pk_bf16_f32 v121, v202, v203
    v_cvt_pk_bf16_f32 v122, v204, v205
    v_cvt_pk_bf16_f32 v123, v206, v207
    s_add_u32 m0, s58, 90112
    s_mul_i32 s45, s61, s71
    buffer_load_dwordx4 v21, s[24:27], s45 offen lds
    v_mfma_f32_32x32x16_bf16 v[184:199], v[232:235], v[132:135], v[240:255]
    v_cvt_pk_bf16_f32 v124, v216, v217
    v_cvt_pk_bf16_f32 v125, v218, v219
    v_cvt_pk_bf16_f32 v126, v220, v221
    v_cvt_pk_bf16_f32 v127, v222, v223
    s_add_u32 m0, s58, 94208
    s_mul_i32 s46, s61, s72
    buffer_load_dwordx4 v22, s[28:31], s46 offen lds
    v_mfma_f32_32x32x16_bf16 v[200:215], v[232:235], v[136:139], v[240:255]
    v_cvt_pk_bf16_f32 v128, v168, v169
    v_cvt_pk_bf16_f32 v129, v170, v171
    v_cvt_pk_bf16_f32 v130, v172, v173
    v_cvt_pk_bf16_f32 v131, v174, v175
    v_mfma_f32_32x32x16_bf16 v[216:231], v[232:235], v[140:143], v[240:255]
    v_cvt_pk_bf16_f32 v132, v184, v185
    v_cvt_pk_bf16_f32 v133, v186, v187
    v_cvt_pk_bf16_f32 v134, v188, v189
    v_cvt_pk_bf16_f32 v135, v190, v191
    v_mfma_f32_32x32x16_bf16 v[168:183], v[232:235], v[144:147], v[240:255]
    s_nop 1
    v_cvt_pk_bf16_f32 v136, v200, v201
    v_cvt_pk_bf16_f32 v137, v202, v203
    v_cvt_pk_bf16_f32 v138, v204, v205
    v_cvt_pk_bf16_f32 v139, v206, v207
    v_mfma_f32_32x32x16_bf16 v[184:199], v[232:235], v[148:151], v[240:255]
    v_cvt_pk_bf16_f32 v140, v216, v217
    v_cvt_pk_bf16_f32 v141, v218, v219
    v_cvt_pk_bf16_f32 v142, v220, v221
    v_cvt_pk_bf16_f32 v143, v222, v223
    v_mfma_f32_32x32x16_bf16 v[200:215], v[232:235], v[152:155], v[240:255]
    v_cvt_pk_bf16_f32 v144, v168, v169
    v_cvt_pk_bf16_f32 v145, v170, v171
    v_cvt_pk_bf16_f32 v146, v172, v173
    v_cvt_pk_bf16_f32 v147, v174, v175
    v_mfma_f32_32x32x16_bf16 v[216:231], v[232:235], v[156:159], v[240:255]
    s_nop 1
    v_cvt_pk_bf16_f32 v148, v184, v185
    v_cvt_pk_bf16_f32 v149, v186, v187
    v_cvt_pk_bf16_f32 v150, v188, v189
    v_cvt_pk_bf16_f32 v151, v190, v191
    s_nop 0
    v_cvt_pk_bf16_f32 v152, v200, v201
    v_cvt_pk_bf16_f32 v153, v202, v203
    v_cvt_pk_bf16_f32 v154, v204, v205
    v_cvt_pk_bf16_f32 v155, v206, v207
    s_nop 0
    v_cvt_pk_bf16_f32 v156, v216, v217
    v_cvt_pk_bf16_f32 v157, v218, v219
    v_cvt_pk_bf16_f32 v158, v220, v221
    v_cvt_pk_bf16_f32 v159, v222, v223
    s_waitcnt vmcnt(12)
    s_barrier
    ds_read_b64_tr_b16 a[64:65], v10 offset:0
    ds_read_b64_tr_b16 a[66:67], v10 offset:1024
    ds_read_b64_tr_b16 a[68:69], v11 offset:0
    ds_read_b64_tr_b16 a[70:71], v11 offset:1024
    ds_read_b64_tr_b16 a[72:73], v12 offset:0
    ds_read_b64_tr_b16 a[74:75], v12 offset:1024
    ds_read_b64_tr_b16 a[76:77], v13 offset:0
    ds_read_b64_tr_b16 a[78:79], v13 offset:1024
    ds_read_b64_tr_b16 a[80:81], v14 offset:0
    ds_read_b64_tr_b16 a[82:83], v14 offset:1024
    ds_read_b64_tr_b16 a[84:85], v15 offset:0
    ds_read_b64_tr_b16 a[86:87], v15 offset:1024
    .p2align 3
    s_waitcnt lgkmcnt(0)
    v_mfma_f32_32x32x16_bf16 v[160:175], a[64:67], v[32:35], 0
    ds_read_b64_tr_b16 a[88:89], v10 offset:2048
    ds_read_b64_tr_b16 a[90:91], v10 offset:3072
    ds_read_b64_tr_b16 a[92:93], v11 offset:2048
    ds_read_b64_tr_b16 a[94:95], v11 offset:3072
    v_mfma_f32_32x32x16_bf16 v[176:191], a[68:71], v[32:35], 0
    ds_read_b64_tr_b16 a[96:97], v12 offset:2048
    ds_read_b64_tr_b16 a[98:99], v12 offset:3072
    ds_read_b64_tr_b16 a[100:101], v13 offset:2048
    ds_read_b64_tr_b16 a[102:103], v13 offset:3072
    v_mfma_f32_32x32x16_bf16 v[192:207], a[72:75], v[32:35], 0
    ds_read_b64_tr_b16 a[104:105], v14 offset:2048
    ds_read_b64_tr_b16 a[106:107], v14 offset:3072
    ds_read_b64_tr_b16 a[108:109], v15 offset:2048
    ds_read_b64_tr_b16 a[110:111], v15 offset:3072
    v_mfma_f32_32x32x16_bf16 v[208:223], a[76:79], v[32:35], 0
    s_add_u32 s61, s89, 256
    s_and_b32 s61, s61, 511
    s_add_u32 m0, s58, 98304
    s_mul_i32 s44, s61, s70
    buffer_load_dwordx4 v20, s[20:23], s44 offen lds
    v_mfma_f32_32x32x16_bf16 v[224:239], a[80:83], v[32:35], 0
    s_add_u32 m0, s58, 102400
    s_mul_i32 s45, s61, s71
    buffer_load_dwordx4 v21, s[24:27], s45 offen lds
    v_mfma_f32_32x32x16_bf16 v[240:255], a[84:87], v[32:35], 0
    s_waitcnt lgkmcnt(0)
    v_mfma_f32_32x32x16_bf16 v[160:175], a[88:91], v[36:39], v[160:175]
    ds_read_b64_tr_b16 a[64:65], v10 offset:12288
    ds_read_b64_tr_b16 a[66:67], v10 offset:13312
    ds_read_b64_tr_b16 a[68:69], v11 offset:12288
    ds_read_b64_tr_b16 a[70:71], v11 offset:13312
    v_mfma_f32_32x32x16_bf16 v[176:191], a[92:95], v[36:39], v[176:191]
    ds_read_b64_tr_b16 a[72:73], v12 offset:12288
    ds_read_b64_tr_b16 a[74:75], v12 offset:13312
    ds_read_b64_tr_b16 a[76:77], v13 offset:12288
    ds_read_b64_tr_b16 a[78:79], v13 offset:13312
    v_mfma_f32_32x32x16_bf16 v[192:207], a[96:99], v[36:39], v[192:207]
    ds_read_b64_tr_b16 a[80:81], v14 offset:12288
    ds_read_b64_tr_b16 a[82:83], v14 offset:13312
    ds_read_b64_tr_b16 a[84:85], v15 offset:12288
    ds_read_b64_tr_b16 a[86:87], v15 offset:13312
    v_mfma_f32_32x32x16_bf16 v[208:223], a[100:103], v[36:39], v[208:223]
    s_add_u32 m0, s58, 106496
    s_mul_i32 s46, s61, s72
    buffer_load_dwordx4 v22, s[28:31], s46 offen lds
    v_mfma_f32_32x32x16_bf16 v[224:239], a[104:107], v[36:39], v[224:239]
    s_add_u32 s61, s89, 288
    s_and_b32 s61, s61, 511
    s_add_u32 m0, s58, 110592
    s_mul_i32 s44, s61, s70
    buffer_load_dwordx4 v20, s[20:23], s44 offen lds
    v_mfma_f32_32x32x16_bf16 v[240:255], a[108:111], v[36:39], v[240:255]
    s_waitcnt lgkmcnt(0)
    v_mfma_f32_32x32x16_bf16 v[160:175], a[64:67], v[40:43], v[160:175]
    ds_read_b64_tr_b16 a[88:89], v10 offset:14336
    ds_read_b64_tr_b16 a[90:91], v10 offset:15360
    ds_read_b64_tr_b16 a[92:93], v11 offset:14336
    ds_read_b64_tr_b16 a[94:95], v11 offset:15360
    v_mfma_f32_32x32x16_bf16 v[176:191], a[68:71], v[40:43], v[176:191]
    ds_read_b64_tr_b16 a[96:97], v12 offset:14336
    ds_read_b64_tr_b16 a[98:99], v12 offset:15360
    ds_read_b64_tr_b16 a[100:101], v13 offset:14336
    ds_read_b64_tr_b16 a[102:103], v13 offset:15360
    v_mfma_f32_32x32x16_bf16 v[192:207], a[72:75], v[40:43], v[192:207]
    ds_read_b64_tr_b16 a[104:105], v14 offset:14336
    ds_read_b64_tr_b16 a[106:107], v14 offset:15360
    ds_read_b64_tr_b16 a[108:109], v15 offset:14336
    ds_read_b64_tr_b16 a[110:111], v15 offset:15360
    v_mfma_f32_32x32x16_bf16 v[208:223], a[76:79], v[40:43], v[208:223]
    s_add_u32 m0, s58, 114688
    s_mul_i32 s45, s61, s71
    buffer_load_dwordx4 v21, s[24:27], s45 offen lds
    v_mfma_f32_32x32x16_bf16 v[224:239], a[80:83], v[40:43], v[224:239]
    s_add_u32 m0, s58, 118784
    s_mul_i32 s46, s61, s72
    buffer_load_dwordx4 v22, s[28:31], s46 offen lds
    v_mfma_f32_32x32x16_bf16 v[240:255], a[84:87], v[40:43], v[240:255]
    s_waitcnt lgkmcnt(0)
    v_mfma_f32_32x32x16_bf16 v[160:175], a[88:91], v[44:47], v[160:175]
    ds_read_b64_tr_b16 a[64:65], v10 offset:24576
    ds_read_b64_tr_b16 a[66:67], v10 offset:25600
    ds_read_b64_tr_b16 a[68:69], v11 offset:24576
    ds_read_b64_tr_b16 a[70:71], v11 offset:25600
    v_mfma_f32_32x32x16_bf16 v[176:191], a[92:95], v[44:47], v[176:191]
    ds_read_b64_tr_b16 a[72:73], v12 offset:24576
    ds_read_b64_tr_b16 a[74:75], v12 offset:25600
    ds_read_b64_tr_b16 a[76:77], v13 offset:24576
    ds_read_b64_tr_b16 a[78:79], v13 offset:25600
    v_mfma_f32_32x32x16_bf16 v[192:207], a[96:99], v[44:47], v[192:207]
    ds_read_b64_tr_b16 a[80:81], v14 offset:24576
    ds_read_b64_tr_b16 a[82:83], v14 offset:25600
    ds_read_b64_tr_b16 a[84:85], v15 offset:24576
    ds_read_b64_tr_b16 a[86:87], v15 offset:25600
    v_mfma_f32_32x32x16_bf16 v[208:223], a[100:103], v[44:47], v[208:223]
    s_add_u32 s61, s89, 320
    s_and_b32 s61, s61, 511
    s_add_u32 m0, s58, 122880
    s_mul_i32 s44, s61, s70
    buffer_load_dwordx4 v20, s[20:23], s44 offen lds
    v_mfma_f32_32x32x16_bf16 v[224:239], a[104:107], v[44:47], v[224:239]
    s_add_u32 m0, s58, 126976
    s_mul_i32 s45, s61, s71
    buffer_load_dwordx4 v21, s[24:27], s45 offen lds
    v_mfma_f32_32x32x16_bf16 v[240:255], a[108:111], v[44:47], v[240:255]
    s_waitcnt lgkmcnt(0)
    v_mfma_f32_32x32x16_bf16 v[160:175], a[64:67], v[48:51], v[160:175]
    ds_read_b64_tr_b16 a[88:89], v10 offset:26624
    ds_read_b64_tr_b16 a[90:91], v10 offset:27648
    ds_read_b64_tr_b16 a[92:93], v11 offset:26624
    ds_read_b64_tr_b16 a[94:95], v11 offset:27648
    v_mfma_f32_32x32x16_bf16 v[176:191], a[68:71], v[48:51], v[176:191]
    ds_read_b64_tr_b16 a[96:97], v12 offset:26624
    ds_read_b64_tr_b16 a[98:99], v12 offset:27648
    ds_read_b64_tr_b16 a[100:101], v13 offset:26624
    ds_read_b64_tr_b16 a[102:103], v13 offset:27648
    v_mfma_f32_32x32x16_bf16 v[192:207], a[72:75], v[48:51], v[192:207]
    ds_read_b64_tr_b16 a[104:105], v14 offset:26624
    ds_read_b64_tr_b16 a[106:107], v14 offset:27648
    ds_read_b64_tr_b16 a[108:109], v15 offset:26624
    ds_read_b64_tr_b16 a[110:111], v15 offset:27648
    v_mfma_f32_32x32x16_bf16 v[208:223], a[76:79], v[48:51], v[208:223]
    s_add_u32 m0, s58, 131072
    s_mul_i32 s46, s61, s72
    buffer_load_dwordx4 v22, s[28:31], s46 offen lds
    v_mfma_f32_32x32x16_bf16 v[224:239], a[80:83], v[48:51], v[224:239]
    s_add_u32 s61, s89, 352
    s_and_b32 s61, s61, 511
    s_add_u32 m0, s58, 135168
    s_mul_i32 s44, s61, s70
    buffer_load_dwordx4 v20, s[20:23], s44 offen lds
    v_mfma_f32_32x32x16_bf16 v[240:255], a[84:87], v[48:51], v[240:255]
    s_waitcnt lgkmcnt(0)
    v_mfma_f32_32x32x16_bf16 v[160:175], a[88:91], v[52:55], v[160:175]
    ds_read_b64_tr_b16 a[64:65], v10 offset:36864
    ds_read_b64_tr_b16 a[66:67], v10 offset:37888
    ds_read_b64_tr_b16 a[68:69], v11 offset:36864
    ds_read_b64_tr_b16 a[70:71], v11 offset:37888
    v_mfma_f32_32x32x16_bf16 v[176:191], a[92:95], v[52:55], v[176:191]
    ds_read_b64_tr_b16 a[72:73], v12 offset:36864
    ds_read_b64_tr_b16 a[74:75], v12 offset:37888
    ds_read_b64_tr_b16 a[76:77], v13 offset:36864
    ds_read_b64_tr_b16 a[78:79], v13 offset:37888
    v_mfma_f32_32x32x16_bf16 v[192:207], a[96:99], v[52:55], v[192:207]
    ds_read_b64_tr_b16 a[80:81], v14 offset:36864
    ds_read_b64_tr_b16 a[82:83], v14 offset:37888
    ds_read_b64_tr_b16 a[84:85], v15 offset:36864
    ds_read_b64_tr_b16 a[86:87], v15 offset:37888
    v_mfma_f32_32x32x16_bf16 v[208:223], a[100:103], v[52:55], v[208:223]
    s_add_u32 m0, s58, 139264
    s_mul_i32 s45, s61, s71
    buffer_load_dwordx4 v21, s[24:27], s45 offen lds
    v_mfma_f32_32x32x16_bf16 v[224:239], a[104:107], v[52:55], v[224:239]
    s_add_u32 m0, s58, 143360
    s_mul_i32 s46, s61, s72
    buffer_load_dwordx4 v22, s[28:31], s46 offen lds
    v_mfma_f32_32x32x16_bf16 v[240:255], a[108:111], v[52:55], v[240:255]
    s_waitcnt lgkmcnt(0)
    v_mfma_f32_32x32x16_bf16 v[160:175], a[64:67], v[56:59], v[160:175]
    ds_read_b64_tr_b16 a[88:89], v10 offset:38912
    ds_read_b64_tr_b16 a[90:91], v10 offset:39936
    ds_read_b64_tr_b16 a[92:93], v11 offset:38912
    ds_read_b64_tr_b16 a[94:95], v11 offset:39936
    v_mfma_f32_32x32x16_bf16 v[176:191], a[68:71], v[56:59], v[176:191]
    ds_read_b64_tr_b16 a[96:97], v12 offset:38912
    ds_read_b64_tr_b16 a[98:99], v12 offset:39936
    ds_read_b64_tr_b16 a[100:101], v13 offset:38912
    ds_read_b64_tr_b16 a[102:103], v13 offset:39936
    v_mfma_f32_32x32x16_bf16 v[192:207], a[72:75], v[56:59], v[192:207]
    ds_read_b64_tr_b16 a[104:105], v14 offset:38912
    ds_read_b64_tr_b16 a[106:107], v14 offset:39936
    ds_read_b64_tr_b16 a[108:109], v15 offset:38912
    ds_read_b64_tr_b16 a[110:111], v15 offset:39936
    v_mfma_f32_32x32x16_bf16 v[208:223], a[76:79], v[56:59], v[208:223]
    v_mfma_f32_32x32x16_bf16 v[224:239], a[80:83], v[56:59], v[224:239]
    v_mfma_f32_32x32x16_bf16 v[240:255], a[84:87], v[56:59], v[240:255]
    s_waitcnt lgkmcnt(0)
    v_mfma_f32_32x32x16_bf16 v[160:175], a[88:91], v[60:63], v[160:175]
    s_waitcnt vmcnt(12)
    s_barrier
    ds_read_b64_tr_b16 a[64:65], v10 offset:49152
    ds_read_b64_tr_b16 a[66:67], v10 offset:50176
    ds_read_b64_tr_b16 a[68:69], v11 offset:49152
    ds_read_b64_tr_b16 a[70:71], v11 offset:50176
    v_mfma_f32_32x32x16_bf16 v[176:191], a[92:95], v[60:63], v[176:191]
    ds_read_b64_tr_b16 a[72:73], v12 offset:49152
    ds_read_b64_tr_b16 a[74:75], v12 offset:50176
    ds_read_b64_tr_b16 a[76:77], v13 offset:49152
    ds_read_b64_tr_b16 a[78:79], v13 offset:50176
    v_mfma_f32_32x32x16_bf16 v[192:207], a[96:99], v[60:63], v[192:207]
    ds_read_b64_tr_b16 a[80:81], v14 offset:49152
    ds_read_b64_tr_b16 a[82:83], v14 offset:50176
    ds_read_b64_tr_b16 a[84:85], v15 offset:49152
    ds_read_b64_tr_b16 a[86:87], v15 offset:50176
    v_mfma_f32_32x32x16_bf16 v[208:223], a[100:103], v[60:63], v[208:223]
    s_add_u32 s61, s89, 384
    s_and_b32 s61, s61, 511
    s_add_u32 m0, s58, 0
    s_mul_i32 s44, s61, s70
    buffer_load_dwordx4 v20, s[20:23], s44 offen lds
    v_mfma_f32_32x32x16_bf16 v[224:239], a[104:107], v[60:63], v[224:239]
    s_add_u32 m0, s58, 4096
    s_mul_i32 s45, s61, s71
    buffer_load_dwordx4 v21, s[24:27], s45 offen lds
    v_mfma_f32_32x32x16_bf16 v[240:255], a[108:111], v[60:63], v[240:255]
    s_waitcnt lgkmcnt(0)
    v_mfma_f32_32x32x16_bf16 v[160:175], a[64:67], v[64:67], v[160:175]
    ds_read_b64_tr_b16 a[88:89], v10 offset:51200
    ds_read_b64_tr_b16 a[90:91], v10 offset:52224
    ds_read_b64_tr_b16 a[92:93], v11 offset:51200
    ds_read_b64_tr_b16 a[94:95], v11 offset:52224
    v_mfma_f32_32x32x16_bf16 v[176:191], a[68:71], v[64:67], v[176:191]
    ds_read_b64_tr_b16 a[96:97], v12 offset:51200
    ds_read_b64_tr_b16 a[98:99], v12 offset:52224
    ds_read_b64_tr_b16 a[100:101], v13 offset:51200
    ds_read_b64_tr_b16 a[102:103], v13 offset:52224
    v_mfma_f32_32x32x16_bf16 v[192:207], a[72:75], v[64:67], v[192:207]
    ds_read_b64_tr_b16 a[104:105], v14 offset:51200
    ds_read_b64_tr_b16 a[106:107], v14 offset:52224
    ds_read_b64_tr_b16 a[108:109], v15 offset:51200
    ds_read_b64_tr_b16 a[110:111], v15 offset:52224
    v_mfma_f32_32x32x16_bf16 v[208:223], a[76:79], v[64:67], v[208:223]
    s_add_u32 m0, s58, 8192
    s_mul_i32 s46, s61, s72
    buffer_load_dwordx4 v22, s[28:31], s46 offen lds
    v_mfma_f32_32x32x16_bf16 v[224:239], a[80:83], v[64:67], v[224:239]
    s_add_u32 s61, s89, 416
    s_and_b32 s61, s61, 511
    s_add_u32 m0, s58, 12288
    s_mul_i32 s44, s61, s70
    buffer_load_dwordx4 v20, s[20:23], s44 offen lds
    v_mfma_f32_32x32x16_bf16 v[240:255], a[84:87], v[64:67], v[240:255]
    s_waitcnt lgkmcnt(0)
    v_mfma_f32_32x32x16_bf16 v[160:175], a[88:91], v[68:71], v[160:175]
    v_add_u32 v10, 61440, v10
    v_add_u32 v11, 61440, v11
    v_add_u32 v12, 61440, v12
    v_add_u32 v13, 61440, v13
    v_add_u32 v14, 61440, v14
    v_add_u32 v15, 61440, v15
    ds_read_b64_tr_b16 a[64:65], v10 offset:0
    ds_read_b64_tr_b16 a[66:67], v10 offset:1024
    ds_read_b64_tr_b16 a[68:69], v11 offset:0
    ds_read_b64_tr_b16 a[70:71], v11 offset:1024
    v_mfma_f32_32x32x16_bf16 v[176:191], a[92:95], v[68:71], v[176:191]
    ds_read_b64_tr_b16 a[72:73], v12 offset:0
    ds_read_b64_tr_b16 a[74:75], v12 offset:1024
    ds_read_b64_tr_b16 a[76:77], v13 offset:0
    ds_read_b64_tr_b16 a[78:79], v13 offset:1024
    v_mfma_f32_32x32x16_bf16 v[192:207], a[96:99], v[68:71], v[192:207]
    ds_read_b64_tr_b16 a[80:81], v14 offset:0
    ds_read_b64_tr_b16 a[82:83], v14 offset:1024
    ds_read_b64_tr_b16 a[84:85], v15 offset:0
    ds_read_b64_tr_b16 a[86:87], v15 offset:1024
    v_mfma_f32_32x32x16_bf16 v[208:223], a[100:103], v[68:71], v[208:223]
    s_add_u32 m0, s58, 16384
    s_mul_i32 s45, s61, s71
    buffer_load_dwordx4 v21, s[24:27], s45 offen lds
    v_mfma_f32_32x32x16_bf16 v[224:239], a[104:107], v[68:71], v[224:239]
    s_add_u32 m0, s58, 20480
    s_mul_i32 s46, s61, s72
    buffer_load_dwordx4 v22, s[28:31], s46 offen lds
    v_mfma_f32_32x32x16_bf16 v[240:255], a[108:111], v[68:71], v[240:255]
    s_waitcnt lgkmcnt(0)
    v_mfma_f32_32x32x16_bf16 v[160:175], a[64:67], v[72:75], v[160:175]
    ds_read_b64_tr_b16 a[88:89], v10 offset:2048
    ds_read_b64_tr_b16 a[90:91], v10 offset:3072
    ds_read_b64_tr_b16 a[92:93], v11 offset:2048
    ds_read_b64_tr_b16 a[94:95], v11 offset:3072
    v_mfma_f32_32x32x16_bf16 v[176:191], a[68:71], v[72:75], v[176:191]
    ds_read_b64_tr_b16 a[96:97], v12 offset:2048
    ds_read_b64_tr_b16 a[98:99], v12 offset:3072
    ds_read_b64_tr_b16 a[100:101], v13 offset:2048
    ds_read_b64_tr_b16 a[102:103], v13 offset:3072
    v_mfma_f32_32x32x16_bf16 v[192:207], a[72:75], v[72:75], v[192:207]
    ds_read_b64_tr_b16 a[104:105], v14 offset:2048
    ds_read_b64_tr_b16 a[106:107], v14 offset:3072
    ds_read_b64_tr_b16 a[108:109], v15 offset:2048
    ds_read_b64_tr_b16 a[110:111], v15 offset:3072
    v_mfma_f32_32x32x16_bf16 v[208:223], a[76:79], v[72:75], v[208:223]
    s_add_u32 s61, s89, 448
    s_and_b32 s61, s61, 511
    s_add_u32 m0, s58, 24576
    s_mul_i32 s44, s61, s70
    buffer_load_dwordx4 v20, s[20:23], s44 offen lds
    v_mfma_f32_32x32x16_bf16 v[224:239], a[80:83], v[72:75], v[224:239]
    s_add_u32 m0, s58, 28672
    s_mul_i32 s45, s61, s71
    buffer_load_dwordx4 v21, s[24:27], s45 offen lds
    v_mfma_f32_32x32x16_bf16 v[240:255], a[84:87], v[72:75], v[240:255]
    s_waitcnt lgkmcnt(0)
    v_mfma_f32_32x32x16_bf16 v[160:175], a[88:91], v[76:79], v[160:175]
    ds_read_b64_tr_b16 a[64:65], v10 offset:12288
    ds_read_b64_tr_b16 a[66:67], v10 offset:13312
    ds_read_b64_tr_b16 a[68:69], v11 offset:12288
    ds_read_b64_tr_b16 a[70:71], v11 offset:13312
    v_mfma_f32_32x32x16_bf16 v[176:191], a[92:95], v[76:79], v[176:191]
    ds_read_b64_tr_b16 a[72:73], v12 offset:12288
    ds_read_b64_tr_b16 a[74:75], v12 offset:13312
    ds_read_b64_tr_b16 a[76:77], v13 offset:12288
    ds_read_b64_tr_b16 a[78:79], v13 offset:13312
    v_mfma_f32_32x32x16_bf16 v[192:207], a[96:99], v[76:79], v[192:207]
    ds_read_b64_tr_b16 a[80:81], v14 offset:12288
    ds_read_b64_tr_b16 a[82:83], v14 offset:13312
    ds_read_b64_tr_b16 a[84:85], v15 offset:12288
    ds_read_b64_tr_b16 a[86:87], v15 offset:13312
    v_mfma_f32_32x32x16_bf16 v[208:223], a[100:103], v[76:79], v[208:223]
    s_add_u32 m0, s58, 32768
    s_mul_i32 s46, s61, s72
    buffer_load_dwordx4 v22, s[28:31], s46 offen lds
    v_mfma_f32_32x32x16_bf16 v[224:239], a[104:107], v[76:79], v[224:239]
    s_add_u32 s61, s89, 480
    s_and_b32 s61, s61, 511
    s_add_u32 m0, s58, 36864
    s_mul_i32 s44, s61, s70
    buffer_load_dwordx4 v20, s[20:23], s44 offen lds
    v_mfma_f32_32x32x16_bf16 v[240:255], a[108:111], v[76:79], v[240:255]
    s_waitcnt lgkmcnt(0)
    v_mfma_f32_32x32x16_bf16 v[160:175], a[64:67], v[80:83], v[160:175]
    ds_read_b64_tr_b16 a[88:89], v10 offset:14336
    ds_read_b64_tr_b16 a[90:91], v10 offset:15360
    ds_read_b64_tr_b16 a[92:93], v11 offset:14336
    ds_read_b64_tr_b16 a[94:95], v11 offset:15360
    v_mfma_f32_32x32x16_bf16 v[176:191], a[68:71], v[80:83], v[176:191]
    ds_read_b64_tr_b16 a[96:97], v12 offset:14336
    ds_read_b64_tr_b16 a[98:99], v12 offset:15360
    ds_read_b64_tr_b16 a[100:101], v13 offset:14336
    ds_read_b64_tr_b16 a[102:103], v13 offset:15360
    v_mfma_f32_32x32x16_bf16 v[192:207], a[72:75], v[80:83], v[192:207]
    ds_read_b64_tr_b16 a[104:105], v14 offset:14336
    ds_read_b64_tr_b16 a[106:107], v14 offset:15360
    ds_read_b64_tr_b16 a[108:109], v15 offset:14336
    ds_read_b64_tr_b16 a[110:111], v15 offset:15360
    v_mfma_f32_32x32x16_bf16 v[208:223], a[76:79], v[80:83], v[208:223]
    s_add_u32 m0, s58, 40960
    s_mul_i32 s45, s61, s71
    buffer_load_dwordx4 v21, s[24:27], s45 offen lds
    v_mfma_f32_32x32x16_bf16 v[224:239], a[80:83], v[80:83], v[224:239]
    s_add_u32 m0, s58, 45056
    s_mul_i32 s46, s61, s72
    buffer_load_dwordx4 v22, s[28:31], s46 offen lds
    v_mfma_f32_32x32x16_bf16 v[240:255], a[84:87], v[80:83], v[240:255]
    s_waitcnt lgkmcnt(0)
    v_mfma_f32_32x32x16_bf16 v[160:175], a[88:91], v[84:87], v[160:175]
    ds_read_b64_tr_b16 a[64:65], v10 offset:24576
    ds_read_b64_tr_b16 a[66:67], v10 offset:25600
    ds_read_b64_tr_b16 a[68:69], v11 offset:24576
    ds_read_b64_tr_b16 a[70:71], v11 offset:25600
    v_mfma_f32_32x32x16_bf16 v[176:191], a[92:95], v[84:87], v[176:191]
    ds_read_b64_tr_b16 a[72:73], v12 offset:24576
    ds_read_b64_tr_b16 a[74:75], v12 offset:25600
    ds_read_b64_tr_b16 a[76:77], v13 offset:24576
    ds_read_b64_tr_b16 a[78:79], v13 offset:25600
    v_mfma_f32_32x32x16_bf16 v[192:207], a[96:99], v[84:87], v[192:207]
    ds_read_b64_tr_b16 a[80:81], v14 offset:24576
    ds_read_b64_tr_b16 a[82:83], v14 offset:25600
    ds_read_b64_tr_b16 a[84:85], v15 offset:24576
    ds_read_b64_tr_b16 a[86:87], v15 offset:25600
    v_mfma_f32_32x32x16_bf16 v[208:223], a[100:103], v[84:87], v[208:223]
    v_mfma_f32_32x32x16_bf16 v[224:239], a[104:107], v[84:87], v[224:239]
    v_mfma_f32_32x32x16_bf16 v[240:255], a[108:111], v[84:87], v[240:255]
    s_waitcnt lgkmcnt(0)
    v_mfma_f32_32x32x16_bf16 v[160:175], a[64:67], v[88:91], v[160:175]
    ds_read_b64_tr_b16 a[88:89], v10 offset:26624
    ds_read_b64_tr_b16 a[90:91], v10 offset:27648
    ds_read_b64_tr_b16 a[92:93], v11 offset:26624
    ds_read_b64_tr_b16 a[94:95], v11 offset:27648
    v_mfma_f32_32x32x16_bf16 v[176:191], a[68:71], v[88:91], v[176:191]
    ds_read_b64_tr_b16 a[96:97], v12 offset:26624
    ds_read_b64_tr_b16 a[98:99], v12 offset:27648
    ds_read_b64_tr_b16 a[100:101], v13 offset:26624
    ds_read_b64_tr_b16 a[102:103], v13 offset:27648
    v_mfma_f32_32x32x16_bf16 v[192:207], a[72:75], v[88:91], v[192:207]
    ds_read_b64_tr_b16 a[104:105], v14 offset:26624
    ds_read_b64_tr_b16 a[106:107], v14 offset:27648
    ds_read_b64_tr_b16 a[108:109], v15 offset:26624
    ds_read_b64_tr_b16 a[110:111], v15 offset:27648
    v_mfma_f32_32x32x16_bf16 v[208:223], a[76:79], v[88:91], v[208:223]
    v_mfma_f32_32x32x16_bf16 v[224:239], a[80:83], v[88:91], v[224:239]
    v_mfma_f32_32x32x16_bf16 v[240:255], a[84:87], v[88:91], v[240:255]
    s_waitcnt lgkmcnt(0)
    v_mfma_f32_32x32x16_bf16 v[160:175], a[88:91], v[92:95], v[160:175]
    s_waitcnt vmcnt(12)
    s_barrier
    ds_read_b64_tr_b16 a[64:65], v10 offset:36864
    ds_read_b64_tr_b16 a[66:67], v10 offset:37888
    ds_read_b64_tr_b16 a[68:69], v11 offset:36864
    ds_read_b64_tr_b16 a[70:71], v11 offset:37888
    v_mfma_f32_32x32x16_bf16 v[176:191], a[92:95], v[92:95], v[176:191]
    ds_read_b64_tr_b16 a[72:73], v12 offset:36864
    ds_read_b64_tr_b16 a[74:75], v12 offset:37888
    ds_read_b64_tr_b16 a[76:77], v13 offset:36864
    ds_read_b64_tr_b16 a[78:79], v13 offset:37888
    v_mfma_f32_32x32x16_bf16 v[192:207], a[96:99], v[92:95], v[192:207]
    ds_read_b64_tr_b16 a[80:81], v14 offset:36864
    ds_read_b64_tr_b16 a[82:83], v14 offset:37888
    ds_read_b64_tr_b16 a[84:85], v15 offset:36864
    ds_read_b64_tr_b16 a[86:87], v15 offset:37888
    v_mfma_f32_32x32x16_bf16 v[208:223], a[100:103], v[92:95], v[208:223]
    s_add_u32 s61, s89, 0
    s_and_b32 s61, s61, 511
    s_add_u32 m0, s58, 49152
    s_mul_i32 s47, s61, s73
    buffer_load_dwordx4 v23, s[32:35], s47 offen lds
    v_mfma_f32_32x32x16_bf16 v[224:239], a[104:107], v[92:95], v[224:239]
    s_add_u32 m0, s58, 53248
    s_mul_i32 s48, s61, s74
    buffer_load_dwordx4 v24, s[36:39], s48 offen lds
    v_mfma_f32_32x32x16_bf16 v[240:255], a[108:111], v[92:95], v[240:255]
    s_waitcnt lgkmcnt(0)
    v_mfma_f32_32x32x16_bf16 v[160:175], a[64:67], v[96:99], v[160:175]
    ds_read_b64_tr_b16 a[88:89], v10 offset:38912
    ds_read_b64_tr_b16 a[90:91], v10 offset:39936
    ds_read_b64_tr_b16 a[92:93], v11 offset:38912
    ds_read_b64_tr_b16 a[94:95], v11 offset:39936
    v_mfma_f32_32x32x16_bf16 v[176:191], a[68:71], v[96:99], v[176:191]
    ds_read_b64_tr_b16 a[96:97], v12 offset:38912
    ds_read_b64_tr_b16 a[98:99], v12 offset:39936
    ds_read_b64_tr_b16 a[100:101], v13 offset:38912
    ds_read_b64_tr_b16 a[102:103], v13 offset:39936
    v_mfma_f32_32x32x16_bf16 v[192:207], a[72:75], v[96:99], v[192:207]
    ds_read_b64_tr_b16 a[104:105], v14 offset:38912
    ds_read_b64_tr_b16 a[106:107], v14 offset:39936
    ds_read_b64_tr_b16 a[108:109], v15 offset:38912
    ds_read_b64_tr_b16 a[110:111], v15 offset:39936
    v_mfma_f32_32x32x16_bf16 v[208:223], a[76:79], v[96:99], v[208:223]
    s_add_u32 s61, s89, 32
    s_and_b32 s61, s61, 511
    s_add_u32 m0, s58, 61440
    s_mul_i32 s47, s61, s73
    buffer_load_dwordx4 v23, s[32:35], s47 offen lds
    v_mfma_f32_32x32x16_bf16 v[224:239], a[80:83], v[96:99], v[224:239]
    s_add_u32 m0, s58, 65536
    s_mul_i32 s48, s61, s74
    buffer_load_dwordx4 v24, s[36:39], s48 offen lds
    v_mfma_f32_32x32x16_bf16 v[240:255], a[84:87], v[96:99], v[240:255]
    s_waitcnt lgkmcnt(0)
    v_mfma_f32_32x32x16_bf16 v[160:175], a[88:91], v[100:103], v[160:175]
    ds_read_b64_tr_b16 a[64:65], v10 offset:49152
    ds_read_b64_tr_b16 a[66:67], v10 offset:50176
    ds_read_b64_tr_b16 a[68:69], v11 offset:49152
    ds_read_b64_tr_b16 a[70:71], v11 offset:50176
    v_mfma_f32_32x32x16_bf16 v[176:191], a[92:95], v[100:103], v[176:191]
    ds_read_b64_tr_b16 a[72:73], v12 offset:49152
    ds_read_b64_tr_b16 a[74:75], v12 offset:50176
    ds_read_b64_tr_b16 a[76:77], v13 offset:49152
    ds_read_b64_tr_b16 a[78:79], v13 offset:50176
    v_mfma_f32_32x32x16_bf16 v[192:207], a[96:99], v[100:103], v[192:207]
    ds_read_b64_tr_b16 a[80:81], v14 offset:49152
    ds_read_b64_tr_b16 a[82:83], v14 offset:50176
    ds_read_b64_tr_b16 a[84:85], v15 offset:49152
    ds_read_b64_tr_b16 a[86:87], v15 offset:50176
    v_mfma_f32_32x32x16_bf16 v[208:223], a[100:103], v[100:103], v[208:223]
    s_add_u32 s61, s89, 64
    s_and_b32 s61, s61, 511
    s_add_u32 m0, s58, 73728
    s_mul_i32 s47, s61, s73
    buffer_load_dwordx4 v23, s[32:35], s47 offen lds
    v_mfma_f32_32x32x16_bf16 v[224:239], a[104:107], v[100:103], v[224:239]
    s_add_u32 m0, s58, 77824
    s_mul_i32 s48, s61, s74
    buffer_load_dwordx4 v24, s[36:39], s48 offen lds
    v_mfma_f32_32x32x16_bf16 v[240:255], a[108:111], v[100:103], v[240:255]
    s_waitcnt lgkmcnt(0)
    v_mfma_f32_32x32x16_bf16 v[160:175], a[64:67], v[104:107], v[160:175]
    ds_read_b64_tr_b16 a[88:89], v10 offset:51200
    ds_read_b64_tr_b16 a[90:91], v10 offset:52224
    ds_read_b64_tr_b16 a[92:93], v11 offset:51200
    ds_read_b64_tr_b16 a[94:95], v11 offset:52224
    v_mfma_f32_32x32x16_bf16 v[176:191], a[68:71], v[104:107], v[176:191]
    ds_read_b64_tr_b16 a[96:97], v12 offset:51200
    ds_read_b64_tr_b16 a[98:99], v12 offset:52224
    ds_read_b64_tr_b16 a[100:101], v13 offset:51200
    ds_read_b64_tr_b16 a[102:103], v13 offset:52224
    v_mfma_f32_32x32x16_bf16 v[192:207], a[72:75], v[104:107], v[192:207]
    ds_read_b64_tr_b16 a[104:105], v14 offset:51200
    ds_read_b64_tr_b16 a[106:107], v14 offset:52224
    ds_read_b64_tr_b16 a[108:109], v15 offset:51200
    ds_read_b64_tr_b16 a[110:111], v15 offset:52224
    v_mfma_f32_32x32x16_bf16 v[208:223], a[76:79], v[104:107], v[208:223]
    s_add_u32 s61, s89, 96
    s_and_b32 s61, s61, 511
    s_add_u32 m0, s58, 86016
    s_mul_i32 s47, s61, s73
    buffer_load_dwordx4 v23, s[32:35], s47 offen lds
    v_mfma_f32_32x32x16_bf16 v[224:239], a[80:83], v[104:107], v[224:239]
    s_add_u32 m0, s58, 90112
    s_mul_i32 s48, s61, s74
    buffer_load_dwordx4 v24, s[36:39], s48 offen lds
    v_mfma_f32_32x32x16_bf16 v[240:255], a[84:87], v[104:107], v[240:255]
    s_waitcnt lgkmcnt(0)
    v_mfma_f32_32x32x16_bf16 v[160:175], a[88:91], v[108:111], v[160:175]
    v_add_u32 v10, 61440, v10
    v_add_u32 v11, 61440, v11
    v_add_u32 v12, 61440, v12
    v_add_u32 v13, 61440, v13
    v_add_u32 v14, 61440, v14
    v_add_u32 v15, 61440, v15
    ds_read_b64_tr_b16 a[64:65], v10 offset:0
    ds_read_b64_tr_b16 a[66:67], v10 offset:1024
    ds_read_b64_tr_b16 a[68:69], v11 offset:0
    ds_read_b64_tr_b16 a[70:71], v11 offset:1024
    v_mfma_f32_32x32x16_bf16 v[176:191], a[92:95], v[108:111], v[176:191]
    ds_read_b64_tr_b16 a[72:73], v12 offset:0
    ds_read_b64_tr_b16 a[74:75], v12 offset:1024
    ds_read_b64_tr_b16 a[76:77], v13 offset:0
    ds_read_b64_tr_b16 a[78:79], v13 offset:1024
    v_mfma_f32_32x32x16_bf16 v[192:207], a[96:99], v[108:111], v[192:207]
    ds_read_b64_tr_b16 a[80:81], v14 offset:0
    ds_read_b64_tr_b16 a[82:83], v14 offset:1024
    ds_read_b64_tr_b16 a[84:85], v15 offset:0
    ds_read_b64_tr_b16 a[86:87], v15 offset:1024
    v_mfma_f32_32x32x16_bf16 v[208:223], a[100:103], v[108:111], v[208:223]
    v_mfma_f32_32x32x16_bf16 v[224:239], a[104:107], v[108:111], v[224:239]
    v_mfma_f32_32x32x16_bf16 v[240:255], a[108:111], v[108:111], v[240:255]
    s_waitcnt lgkmcnt(0)
    v_mfma_f32_32x32x16_bf16 v[160:175], a[64:67], v[112:115], v[160:175]
    ds_read_b64_tr_b16 a[88:89], v10 offset:2048
    ds_read_b64_tr_b16 a[90:91], v10 offset:3072
    ds_read_b64_tr_b16 a[92:93], v11 offset:2048
    ds_read_b64_tr_b16 a[94:95], v11 offset:3072
    v_mfma_f32_32x32x16_bf16 v[176:191], a[68:71], v[112:115], v[176:191]
    ds_read_b64_tr_b16 a[96:97], v12 offset:2048
    ds_read_b64_tr_b16 a[98:99], v12 offset:3072
    ds_read_b64_tr_b16 a[100:101], v13 offset:2048
    ds_read_b64_tr_b16 a[102:103], v13 offset:3072
    v_mfma_f32_32x32x16_bf16 v[192:207], a[72:75], v[112:115], v[192:207]
    ds_read_b64_tr_b16 a[104:105], v14 offset:2048
    ds_read_b64_tr_b16 a[106:107], v14 offset:3072
    ds_read_b64_tr_b16 a[108:109], v15 offset:2048
    ds_read_b64_tr_b16 a[110:111], v15 offset:3072
    v_mfma_f32_32x32x16_bf16 v[208:223], a[76:79], v[112:115], v[208:223]
    v_mfma_f32_32x32x16_bf16 v[224:239], a[80:83], v[112:115], v[224:239]
    v_mfma_f32_32x32x16_bf16 v[240:255], a[84:87], v[112:115], v[240:255]
    s_waitcnt lgkmcnt(0)
    v_mfma_f32_32x32x16_bf16 v[160:175], a[88:91], v[116:119], v[160:175]
    ds_read_b64_tr_b16 a[64:65], v10 offset:12288
    ds_read_b64_tr_b16 a[66:67], v10 offset:13312
    ds_read_b64_tr_b16 a[68:69], v11 offset:12288
    ds_read_b64_tr_b16 a[70:71], v11 offset:13312
    v_mfma_f32_32x32x16_bf16 v[176:191], a[92:95], v[116:119], v[176:191]
    ds_read_b64_tr_b16 a[72:73], v12 offset:12288
    ds_read_b64_tr_b16 a[74:75], v12 offset:13312
    ds_read_b64_tr_b16 a[76:77], v13 offset:12288
    ds_read_b64_tr_b16 a[78:79], v13 offset:13312
    v_mfma_f32_32x32x16_bf16 v[192:207], a[96:99], v[116:119], v[192:207]
    ds_read_b64_tr_b16 a[80:81], v14 offset:12288
    ds_read_b64_tr_b16 a[82:83], v14 offset:13312
    ds_read_b64_tr_b16 a[84:85], v15 offset:12288
    ds_read_b64_tr_b16 a[86:87], v15 offset:13312
    v_mfma_f32_32x32x16_bf16 v[208:223], a[100:103], v[116:119], v[208:223]
    v_mfma_f32_32x32x16_bf16 v[224:239], a[104:107], v[116:119], v[224:239]
    v_mfma_f32_32x32x16_bf16 v[240:255], a[108:111], v[116:119], v[240:255]
    s_waitcnt lgkmcnt(0)
    v_mfma_f32_32x32x16_bf16 v[160:175], a[64:67], v[120:123], v[160:175]
    ds_read_b64_tr_b16 a[88:89], v10 offset:14336
    ds_read_b64_tr_b16 a[90:91], v10 offset:15360
    ds_read_b64_tr_b16 a[92:93], v11 offset:14336
    ds_read_b64_tr_b16 a[94:95], v11 offset:15360
    v_mfma_f32_32x32x16_bf16 v[176:191], a[68:71], v[120:123], v[176:191]
    ds_read_b64_tr_b16 a[96:97], v12 offset:14336
    ds_read_b64_tr_b16 a[98:99], v12 offset:15360
    ds_read_b64_tr_b16 a[100:101], v13 offset:14336
    ds_read_b64_tr_b16 a[102:103], v13 offset:15360
    v_mfma_f32_32x32x16_bf16 v[192:207], a[72:75], v[120:123], v[192:207]
    ds_read_b64_tr_b16 a[104:105], v14 offset:14336
    ds_read_b64_tr_b16 a[106:107], v14 offset:15360
    ds_read_b64_tr_b16 a[108:109], v15 offset:14336
    ds_read_b64_tr_b16 a[110:111], v15 offset:15360
    v_mfma_f32_32x32x16_bf16 v[208:223], a[76:79], v[120:123], v[208:223]
    v_mfma_f32_32x32x16_bf16 v[224:239], a[80:83], v[120:123], v[224:239]
    v_mfma_f32_32x32x16_bf16 v[240:255], a[84:87], v[120:123], v[240:255]
    s_waitcnt lgkmcnt(0)
    v_mfma_f32_32x32x16_bf16 v[160:175], a[88:91], v[124:127], v[160:175]
    s_waitcnt vmcnt(8)
    s_barrier
    v_add_u32 v10, 4294844416, v10
    v_add_u32 v11, 4294844416, v11
    v_add_u32 v12, 4294844416, v12
    v_add_u32 v13, 4294844416, v13
    v_add_u32 v14, 4294844416, v14
    v_add_u32 v15, 4294844416, v15
    ds_read_b64_tr_b16 a[64:65], v10 offset:0
    ds_read_b64_tr_b16 a[66:67], v10 offset:1024
    ds_read_b64_tr_b16 a[68:69], v11 offset:0
    ds_read_b64_tr_b16 a[70:71], v11 offset:1024
    v_mfma_f32_32x32x16_bf16 v[176:191], a[92:95], v[124:127], v[176:191]
    ds_read_b64_tr_b16 a[72:73], v12 offset:0
    ds_read_b64_tr_b16 a[74:75], v12 offset:1024
    ds_read_b64_tr_b16 a[76:77], v13 offset:0
    ds_read_b64_tr_b16 a[78:79], v13 offset:1024
    v_mfma_f32_32x32x16_bf16 v[192:207], a[96:99], v[124:127], v[192:207]
    ds_read_b64_tr_b16 a[80:81], v14 offset:0
    ds_read_b64_tr_b16 a[82:83], v14 offset:1024
    ds_read_b64_tr_b16 a[84:85], v15 offset:0
    ds_read_b64_tr_b16 a[86:87], v15 offset:1024
    v_mfma_f32_32x32x16_bf16 v[208:223], a[100:103], v[124:127], v[208:223]
    s_add_u32 s61, s89, 128
    s_and_b32 s61, s61, 511
    s_add_u32 m0, s58, 98304
    s_mul_i32 s47, s61, s73
    buffer_load_dwordx4 v23, s[32:35], s47 offen lds
    v_mfma_f32_32x32x16_bf16 v[224:239], a[104:107], v[124:127], v[224:239]
    s_add_u32 m0, s58, 102400
    s_mul_i32 s48, s61, s74
    buffer_load_dwordx4 v24, s[36:39], s48 offen lds
    v_mfma_f32_32x32x16_bf16 v[240:255], a[108:111], v[124:127], v[240:255]
    s_waitcnt lgkmcnt(0)
    v_mfma_f32_32x32x16_bf16 v[160:175], a[64:67], v[128:131], v[160:175]
    ds_read_b64_tr_b16 a[88:89], v10 offset:2048
    ds_read_b64_tr_b16 a[90:91], v10 offset:3072
    ds_read_b64_tr_b16 a[92:93], v11 offset:2048
    ds_read_b64_tr_b16 a[94:95], v11 offset:3072
    v_mfma_f32_32x32x16_bf16 v[176:191], a[68:71], v[128:131], v[176:191]
    ds_read_b64_tr_b16 a[96:97], v12 offset:2048
    ds_read_b64_tr_b16 a[98:99], v12 offset:3072
    ds_read_b64_tr_b16 a[100:101], v13 offset:2048
    ds_read_b64_tr_b16 a[102:103], v13 offset:3072
    v_mfma_f32_32x32x16_bf16 v[192:207], a[72:75], v[128:131], v[192:207]
    ds_read_b64_tr_b16 a[104:105], v14 offset:2048
    ds_read_b64_tr_b16 a[106:107], v14 offset:3072
    ds_read_b64_tr_b16 a[108:109], v15 offset:2048
    ds_read_b64_tr_b16 a[110:111], v15 offset:3072
    v_mfma_f32_32x32x16_bf16 v[208:223], a[76:79], v[128:131], v[208:223]
    s_add_u32 s61, s89, 160
    s_and_b32 s61, s61, 511
    s_add_u32 m0, s58, 110592
    s_mul_i32 s47, s61, s73
    buffer_load_dwordx4 v23, s[32:35], s47 offen lds
    v_mfma_f32_32x32x16_bf16 v[224:239], a[80:83], v[128:131], v[224:239]
    s_add_u32 m0, s58, 114688
    s_mul_i32 s48, s61, s74
    buffer_load_dwordx4 v24, s[36:39], s48 offen lds
    v_mfma_f32_32x32x16_bf16 v[240:255], a[84:87], v[128:131], v[240:255]
    s_waitcnt lgkmcnt(0)
    v_mfma_f32_32x32x16_bf16 v[160:175], a[88:91], v[132:135], v[160:175]
    ds_read_b64_tr_b16 a[64:65], v10 offset:12288
    ds_read_b64_tr_b16 a[66:67], v10 offset:13312
    ds_read_b64_tr_b16 a[68:69], v11 offset:12288
    ds_read_b64_tr_b16 a[70:71], v11 offset:13312
    v_mfma_f32_32x32x16_bf16 v[176:191], a[92:95], v[132:135], v[176:191]
    ds_read_b64_tr_b16 a[72:73], v12 offset:12288
    ds_read_b64_tr_b16 a[74:75], v12 offset:13312
    ds_read_b64_tr_b16 a[76:77], v13 offset:12288
    ds_read_b64_tr_b16 a[78:79], v13 offset:13312
    v_mfma_f32_32x32x16_bf16 v[192:207], a[96:99], v[132:135], v[192:207]
    ds_read_b64_tr_b16 a[80:81], v14 offset:12288
    ds_read_b64_tr_b16 a[82:83], v14 offset:13312
    ds_read_b64_tr_b16 a[84:85], v15 offset:12288
    ds_read_b64_tr_b16 a[86:87], v15 offset:13312
    v_mfma_f32_32x32x16_bf16 v[208:223], a[100:103], v[132:135], v[208:223]
    s_add_u32 s61, s89, 192
    s_and_b32 s61, s61, 511
    s_add_u32 m0, s58, 122880
    s_mul_i32 s47, s61, s73
    buffer_load_dwordx4 v23, s[32:35], s47 offen lds
    v_mfma_f32_32x32x16_bf16 v[224:239], a[104:107], v[132:135], v[224:239]
    s_add_u32 m0, s58, 126976
    s_mul_i32 s48, s61, s74
    buffer_load_dwordx4 v24, s[36:39], s48 offen lds
    v_mfma_f32_32x32x16_bf16 v[240:255], a[108:111], v[132:135], v[240:255]
    s_waitcnt lgkmcnt(0)
    v_mfma_f32_32x32x16_bf16 v[160:175], a[64:67], v[136:139], v[160:175]
    ds_read_b64_tr_b16 a[88:89], v10 offset:14336
    ds_read_b64_tr_b16 a[90:91], v10 offset:15360
    ds_read_b64_tr_b16 a[92:93], v11 offset:14336
    ds_read_b64_tr_b16 a[94:95], v11 offset:15360
    v_mfma_f32_32x32x16_bf16 v[176:191], a[68:71], v[136:139], v[176:191]
    ds_read_b64_tr_b16 a[96:97], v12 offset:14336
    ds_read_b64_tr_b16 a[98:99], v12 offset:15360
    ds_read_b64_tr_b16 a[100:101], v13 offset:14336
    ds_read_b64_tr_b16 a[102:103], v13 offset:15360
    v_mfma_f32_32x32x16_bf16 v[192:207], a[72:75], v[136:139], v[192:207]
    ds_read_b64_tr_b16 a[104:105], v14 offset:14336
    ds_read_b64_tr_b16 a[106:107], v14 offset:15360
    ds_read_b64_tr_b16 a[108:109], v15 offset:14336
    ds_read_b64_tr_b16 a[110:111], v15 offset:15360
    v_mfma_f32_32x32x16_bf16 v[208:223], a[76:79], v[136:139], v[208:223]
    s_add_u32 s61, s89, 224
    s_and_b32 s61, s61, 511
    s_add_u32 m0, s58, 135168
    s_mul_i32 s47, s61, s73
    buffer_load_dwordx4 v23, s[32:35], s47 offen lds
    v_mfma_f32_32x32x16_bf16 v[224:239], a[80:83], v[136:139], v[224:239]
    s_add_u32 m0, s58, 139264
    s_mul_i32 s48, s61, s74
    buffer_load_dwordx4 v24, s[36:39], s48 offen lds
    v_mfma_f32_32x32x16_bf16 v[240:255], a[84:87], v[136:139], v[240:255]
    s_waitcnt lgkmcnt(0)
    v_mfma_f32_32x32x16_bf16 v[160:175], a[88:91], v[140:143], v[160:175]
    ds_read_b64_tr_b16 a[64:65], v10 offset:24576
    ds_read_b64_tr_b16 a[66:67], v10 offset:25600
    ds_read_b64_tr_b16 a[68:69], v11 offset:24576
    ds_read_b64_tr_b16 a[70:71], v11 offset:25600
    v_mfma_f32_32x32x16_bf16 v[176:191], a[92:95], v[140:143], v[176:191]
    ds_read_b64_tr_b16 a[72:73], v12 offset:24576
    ds_read_b64_tr_b16 a[74:75], v12 offset:25600
    ds_read_b64_tr_b16 a[76:77], v13 offset:24576
    ds_read_b64_tr_b16 a[78:79], v13 offset:25600
    v_mfma_f32_32x32x16_bf16 v[192:207], a[96:99], v[140:143], v[192:207]
    ds_read_b64_tr_b16 a[80:81], v14 offset:24576
    ds_read_b64_tr_b16 a[82:83], v14 offset:25600
    ds_read_b64_tr_b16 a[84:85], v15 offset:24576
    ds_read_b64_tr_b16 a[86:87], v15 offset:25600
    v_mfma_f32_32x32x16_bf16 v[208:223], a[100:103], v[140:143], v[208:223]
    v_mfma_f32_32x32x16_bf16 v[224:239], a[104:107], v[140:143], v[224:239]
    v_mfma_f32_32x32x16_bf16 v[240:255], a[108:111], v[140:143], v[240:255]
    s_waitcnt lgkmcnt(0)
    v_mfma_f32_32x32x16_bf16 v[160:175], a[64:67], v[144:147], v[160:175]
    ds_read_b64_tr_b16 a[88:89], v10 offset:26624
    ds_read_b64_tr_b16 a[90:91], v10 offset:27648
    ds_read_b64_tr_b16 a[92:93], v11 offset:26624
    ds_read_b64_tr_b16 a[94:95], v11 offset:27648
    v_mfma_f32_32x32x16_bf16 v[176:191], a[68:71], v[144:147], v[176:191]
    ds_read_b64_tr_b16 a[96:97], v12 offset:26624
    ds_read_b64_tr_b16 a[98:99], v12 offset:27648
    ds_read_b64_tr_b16 a[100:101], v13 offset:26624
    ds_read_b64_tr_b16 a[102:103], v13 offset:27648
    v_mfma_f32_32x32x16_bf16 v[192:207], a[72:75], v[144:147], v[192:207]
    ds_read_b64_tr_b16 a[104:105], v14 offset:26624
    ds_read_b64_tr_b16 a[106:107], v14 offset:27648
    ds_read_b64_tr_b16 a[108:109], v15 offset:26624
    ds_read_b64_tr_b16 a[110:111], v15 offset:27648
    v_mfma_f32_32x32x16_bf16 v[208:223], a[76:79], v[144:147], v[208:223]
    v_mfma_f32_32x32x16_bf16 v[224:239], a[80:83], v[144:147], v[224:239]
    v_mfma_f32_32x32x16_bf16 v[240:255], a[84:87], v[144:147], v[240:255]
    s_waitcnt lgkmcnt(0)
    v_mfma_f32_32x32x16_bf16 v[160:175], a[88:91], v[148:151], v[160:175]
    ds_read_b64_tr_b16 a[64:65], v10 offset:36864
    ds_read_b64_tr_b16 a[66:67], v10 offset:37888
    ds_read_b64_tr_b16 a[68:69], v11 offset:36864
    ds_read_b64_tr_b16 a[70:71], v11 offset:37888
    v_mfma_f32_32x32x16_bf16 v[176:191], a[92:95], v[148:151], v[176:191]
    ds_read_b64_tr_b16 a[72:73], v12 offset:36864
    ds_read_b64_tr_b16 a[74:75], v12 offset:37888
    ds_read_b64_tr_b16 a[76:77], v13 offset:36864
    ds_read_b64_tr_b16 a[78:79], v13 offset:37888
    v_mfma_f32_32x32x16_bf16 v[192:207], a[96:99], v[148:151], v[192:207]
    ds_read_b64_tr_b16 a[80:81], v14 offset:36864
    ds_read_b64_tr_b16 a[82:83], v14 offset:37888
    ds_read_b64_tr_b16 a[84:85], v15 offset:36864
    ds_read_b64_tr_b16 a[86:87], v15 offset:37888
    v_mfma_f32_32x32x16_bf16 v[208:223], a[100:103], v[148:151], v[208:223]
    v_mfma_f32_32x32x16_bf16 v[224:239], a[104:107], v[148:151], v[224:239]
    v_mfma_f32_32x32x16_bf16 v[240:255], a[108:111], v[148:151], v[240:255]
    s_waitcnt lgkmcnt(0)
    v_mfma_f32_32x32x16_bf16 v[160:175], a[64:67], v[152:155], v[160:175]
    ds_read_b64_tr_b16 a[88:89], v10 offset:38912
    ds_read_b64_tr_b16 a[90:91], v10 offset:39936
    ds_read_b64_tr_b16 a[92:93], v11 offset:38912
    ds_read_b64_tr_b16 a[94:95], v11 offset:39936
    v_mfma_f32_32x32x16_bf16 v[176:191], a[68:71], v[152:155], v[176:191]
    ds_read_b64_tr_b16 a[96:97], v12 offset:38912
    ds_read_b64_tr_b16 a[98:99], v12 offset:39936
    ds_read_b64_tr_b16 a[100:101], v13 offset:38912
    ds_read_b64_tr_b16 a[102:103], v13 offset:39936
    v_mfma_f32_32x32x16_bf16 v[192:207], a[72:75], v[152:155], v[192:207]
    ds_read_b64_tr_b16 a[104:105], v14 offset:38912
    ds_read_b64_tr_b16 a[106:107], v14 offset:39936
    ds_read_b64_tr_b16 a[108:109], v15 offset:38912
    ds_read_b64_tr_b16 a[110:111], v15 offset:39936
    v_mfma_f32_32x32x16_bf16 v[208:223], a[76:79], v[152:155], v[208:223]
    v_mfma_f32_32x32x16_bf16 v[224:239], a[80:83], v[152:155], v[224:239]
    v_mfma_f32_32x32x16_bf16 v[240:255], a[84:87], v[152:155], v[240:255]
    s_waitcnt lgkmcnt(0)
    v_mfma_f32_32x32x16_bf16 v[160:175], a[88:91], v[156:159], v[160:175]
    s_waitcnt vmcnt(8)
    s_barrier
    ds_read_b64_tr_b16 a[64:65], v10 offset:49152
    ds_read_b64_tr_b16 a[66:67], v10 offset:50176
    ds_read_b64_tr_b16 a[68:69], v11 offset:49152
    ds_read_b64_tr_b16 a[70:71], v11 offset:50176
    v_mfma_f32_32x32x16_bf16 v[176:191], a[92:95], v[156:159], v[176:191]
    ds_read_b64_tr_b16 a[72:73], v12 offset:49152
    ds_read_b64_tr_b16 a[74:75], v12 offset:50176
    ds_read_b64_tr_b16 a[76:77], v13 offset:49152
    ds_read_b64_tr_b16 a[78:79], v13 offset:50176
    v_mfma_f32_32x32x16_bf16 v[192:207], a[96:99], v[156:159], v[192:207]
    v_mfma_f32_32x32x16_bf16 v[208:223], a[100:103], v[156:159], v[208:223]
    s_add_u32 s61, s89, 256
    s_and_b32 s61, s61, 511
    s_add_u32 m0, s58, 0
    s_mul_i32 s47, s61, s73
    buffer_load_dwordx4 v23, s[32:35], s47 offen lds
    v_mfma_f32_32x32x16_bf16 v[224:239], a[104:107], v[156:159], v[224:239]
    s_add_u32 m0, s58, 4096
    s_mul_i32 s48, s61, s74
    buffer_load_dwordx4 v24, s[36:39], s48 offen lds
    v_mfma_f32_32x32x16_bf16 v[240:255], a[108:111], v[156:159], v[240:255]
    s_cmp_ge_u32 s56, 14
    s_cbranch_scc1 .Lk1_p2B
    .p2align 3
    s_waitcnt lgkmcnt(0)
    v_mfma_f32_32x32x16_bf16 a[0:15], a[64:67], v[32:35], 0
    ds_read_b64_tr_b16 a[88:89], v10 offset:51200
    ds_read_b64_tr_b16 a[90:91], v10 offset:52224
    ds_read_b64_tr_b16 a[92:93], v11 offset:51200
    ds_read_b64_tr_b16 a[94:95], v11 offset:52224
    v_mfma_f32_32x32x16_bf16 a[16:31], a[68:71], v[32:35], 0
    ds_read_b64_tr_b16 a[96:97], v12 offset:51200
    ds_read_b64_tr_b16 a[98:99], v12 offset:52224
    ds_read_b64_tr_b16 a[100:101], v13 offset:51200
    ds_read_b64_tr_b16 a[102:103], v13 offset:52224
    v_mfma_f32_32x32x16_bf16 a[32:47], a[72:75], v[32:35], 0
    s_add_u32 s61, s89, 288
    s_and_b32 s61, s61, 511
    s_add_u32 m0, s58, 12288
    s_mul_i32 s47, s61, s73
    buffer_load_dwordx4 v23, s[32:35], s47 offen lds
    v_mfma_f32_32x32x16_bf16 a[48:63], a[76:79], v[32:35], 0
    s_add_u32 m0, s58, 16384
    s_mul_i32 s48, s61, s74
    buffer_load_dwordx4 v24, s[36:39], s48 offen lds
    s_waitcnt lgkmcnt(0)
    v_mfma_f32_32x32x16_bf16 a[0:15], a[88:91], v[36:39], a[0:15]
    v_add_u32 v10, 61440, v10
    v_add_u32 v11, 61440, v11
    v_add_u32 v12, 61440, v12
    v_add_u32 v13, 61440, v13
    v_add_u32 v14, 61440, v14
    v_add_u32 v15, 61440, v15
    ds_read_b64_tr_b16 a[64:65], v10 offset:0
    ds_read_b64_tr_b16 a[66:67], v10 offset:1024
    ds_read_b64_tr_b16 a[68:69], v11 offset:0
    ds_read_b64_tr_b16 a[70:71], v11 offset:1024
    v_mfma_f32_32x32x16_bf16 a[16:31], a[92:95], v[36:39], a[16:31]
    ds_read_b64_tr_b16 a[72:73], v12 offset:0
    ds_read_b64_tr_b16 a[74:75], v12 offset:1024
    ds_read_b64_tr_b16 a[76:77], v13 offset:0
    ds_read_b64_tr_b16 a[78:79], v13 offset:1024
    v_mfma_f32_32x32x16_bf16 a[32:47], a[96:99], v[36:39], a[32:47]
    s_add_u32 s61, s89, 320
    s_and_b32 s61, s61, 511
    s_add_u32 m0, s58, 24576
    s_mul_i32 s47, s61, s73
    buffer_load_dwordx4 v23, s[32:35], s47 offen lds
    v_mov_b32 v4, -1
    v_mov_b32 v5, -1
    v_mov_b32 v6, -1
    v_mfma_f32_32x32x16_bf16 a[48:63], a[100:103], v[36:39], a[48:63]
    s_add_u32 m0, s58, 28672
    s_mul_i32 s48, s61, s74
    buffer_load_dwordx4 v24, s[36:39], s48 offen lds
    v_mov_b32 v7, -1
    s_lshl_b32 s84, s2, 13
    s_lshl_b32 s63, s54, 11
    s_add_u32 s84, s84, s63
    s_waitcnt lgkmcnt(0)
    v_mfma_f32_32x32x16_bf16 a[0:15], a[64:67], v[40:43], a[0:15]
    ds_read_b64_tr_b16 a[88:89], v10 offset:2048
    ds_read_b64_tr_b16 a[90:91], v10 offset:3072
    ds_read_b64_tr_b16 a[92:93], v11 offset:2048
    ds_read_b64_tr_b16 a[94:95], v11 offset:3072
    v_mfma_f32_32x32x16_bf16 a[16:31], a[68:71], v[40:43], a[16:31]
    ds_read_b64_tr_b16 a[96:97], v12 offset:2048
    ds_read_b64_tr_b16 a[98:99], v12 offset:3072
    ds_read_b64_tr_b16 a[100:101], v13 offset:2048
    ds_read_b64_tr_b16 a[102:103], v13 offset:3072
    v_mfma_f32_32x32x16_bf16 a[32:47], a[72:75], v[40:43], a[32:47]
    s_add_u32 s61, s89, 352
    s_and_b32 s61, s61, 511
    s_add_u32 m0, s58, 36864
    s_mul_i32 s47, s61, s73
    buffer_load_dwordx4 v23, s[32:35], s47 offen lds
    s_add_u32 s84, s84, 14680064
    buffer_store_dwordx4 v[4:7], v30, s[40:43], s84 offen sc1
    buffer_store_dwordx4 v[4:7], v30, s[40:43], s84 offen offset:1024 sc1
    v_mfma_f32_32x32x16_bf16 a[48:63], a[76:79], v[40:43], a[48:63]
    s_add_u32 m0, s58, 40960
    s_mul_i32 s48, s61, s74
    buffer_load_dwordx4 v24, s[36:39], s48 offen lds
    v_mul_f32 v26, v25, v25
    v_mul_f32 v160, v160, v168
    v_mul_f32 v161, v161, v169
    v_mul_f32_e64 v162, v162, v170
    s_waitcnt lgkmcnt(0)
    v_mfma_f32_32x32x16_bf16 a[0:15], a[88:91], v[44:47], a[0:15]
    ds_read_b64_tr_b16 a[64:65], v10 offset:12288
    ds_read_b64_tr_b16 a[66:67], v10 offset:13312
    ds_read_b64_tr_b16 a[68:69], v11 offset:12288
    ds_read_b64_tr_b16 a[70:71], v11 offset:13312
    v_mfma_f32_32x32x16_bf16 a[16:31], a[92:95], v[44:47], a[16:31]
    ds_read_b64_tr_b16 a[72:73], v12 offset:12288
    ds_read_b64_tr_b16 a[74:75], v12 offset:13312
    ds_read_b64_tr_b16 a[76:77], v13 offset:12288
    ds_read_b64_tr_b16 a[78:79], v13 offset:13312
    v_mfma_f32_32x32x16_bf16 a[32:47], a[96:99], v[44:47], a[32:47]
    v_mul_f32 v163, v163, v171
    v_mul_f32 v164, v164, v172
    v_mul_f32_e64 v165, v165, v173
    v_mfma_f32_32x32x16_bf16 a[48:63], a[100:103], v[44:47], a[48:63]
    v_mul_f32 v166, v166, v174
    v_mul_f32 v167, v167, v175
    v_mul_f32 v160, v160, v26
    v_mul_f32_e64 v161, v161, v26
    s_waitcnt lgkmcnt(0)
    v_mfma_f32_32x32x16_bf16 a[0:15], a[64:67], v[48:51], a[0:15]
    ds_read_b64_tr_b16 a[88:89], v10 offset:14336
    ds_read_b64_tr_b16 a[90:91], v10 offset:15360
    ds_read_b64_tr_b16 a[92:93], v11 offset:14336
    ds_read_b64_tr_b16 a[94:95], v11 offset:15360
    v_mfma_f32_32x32x16_bf16 a[16:31], a[68:71], v[48:51], a[16:31]
    ds_read_b64_tr_b16 a[96:97], v12 offset:14336
    ds_read_b64_tr_b16 a[98:99], v12 offset:15360
    ds_read_b64_tr_b16 a[100:101], v13 offset:14336
    ds_read_b64_tr_b16 a[102:103], v13 offset:15360
    v_mfma_f32_32x32x16_bf16 a[32:47], a[72:75], v[48:51], a[32:47]
    v_mul_f32 v162, v162, v26
    v_mul_f32 v163, v163, v26
    v_mul_f32_e64 v164, v164, v26
    v_mfma_f32_32x32x16_bf16 a[48:63], a[76:79], v[48:51], a[48:63]
    v_mul_f32 v165, v165, v26
    v_mul_f32 v166, v166, v26
    v_mul_f32_e64 v167, v167, v26
    v_cvt_pk_bf16_f32 v168, v160, v161
    s_waitcnt lgkmcnt(0)
    v_mfma_f32_32x32x16_bf16 a[0:15], a[88:91], v[52:55], a[0:15]
    ds_read_b64_tr_b16 a[64:65], v10 offset:24576
    ds_read_b64_tr_b16 a[66:67], v10 offset:25600
    ds_read_b64_tr_b16 a[68:69], v11 offset:24576
    ds_read_b64_tr_b16 a[70:71], v11 offset:25600
    v_mfma_f32_32x32x16_bf16 a[16:31], a[92:95], v[52:55], a[16:31]
    ds_read_b64_tr_b16 a[72:73], v12 offset:24576
    ds_read_b64_tr_b16 a[74:75], v12 offset:25600
    ds_read_b64_tr_b16 a[76:77], v13 offset:24576
    ds_read_b64_tr_b16 a[78:79], v13 offset:25600
    v_mfma_f32_32x32x16_bf16 a[32:47], a[96:99], v[52:55], a[32:47]
    v_cvt_pk_bf16_f32 v169, v162, v163
    v_cvt_pk_bf16_f32 v170, v164, v165
    v_cvt_pk_bf16_f32 v171, v166, v167
    v_mfma_f32_32x32x16_bf16 a[48:63], a[100:103], v[52:55], a[48:63]
    s_add_u32 s62, s69, 0
    buffer_store_dwordx4 v[168:171], v30, s[40:43], s62 offen sc1
    v_mul_f32 v176, v176, v184
    v_mul_f32_e64 v177, v177, v185
    s_waitcnt lgkmcnt(0)
    v_mfma_f32_32x32x16_bf16 a[0:15], a[64:67], v[56:59], a[0:15]
    ds_read_b64_tr_b16 a[88:89], v10 offset:26624
    ds_read_b64_tr_b16 a[90:91], v10 offset:27648
    ds_read_b64_tr_b16 a[92:93], v11 offset:26624
    ds_read_b64_tr_b16 a[94:95], v11 offset:27648
    v_mfma_f32_32x32x16_bf16 a[16:31], a[68:71], v[56:59], a[16:31]
    ds_read_b64_tr_b16 a[96:97], v12 offset:26624
    ds_read_b64_tr_b16 a[98:99], v12 offset:27648
    ds_read_b64_tr_b16 a[100:101], v13 offset:26624
    ds_read_b64_tr_b16 a[102:103], v13 offset:27648
    v_mfma_f32_32x32x16_bf16 a[32:47], a[72:75], v[56:59], a[32:47]
    v_mul_f32 v178, v178, v186
    v_mul_f32 v179, v179, v187
    v_mul_f32_e64 v180, v180, v188
    v_mfma_f32_32x32x16_bf16 a[48:63], a[76:79], v[56:59], a[48:63]
    v_mul_f32 v181, v181, v189
    v_mul_f32 v182, v182, v190
    v_mul_f32 v183, v183, v191
    v_mul_f32_e64 v176, v176, v26
    s_waitcnt lgkmcnt(0)
    v_mfma_f32_32x32x16_bf16 a[0:15], a[88:91], v[60:63], a[0:15]
    s_waitcnt vmcnt(11)
    s_barrier
    ds_read_b64_tr_b16 a[64:65], v10 offset:36864
    ds_read_b64_tr_b16 a[66:67], v10 offset:37888
    ds_read_b64_tr_b16 a[68:69], v11 offset:36864
    ds_read_b64_tr_b16 a[70:71], v11 offset:37888
    v_mfma_f32_32x32x16_bf16 a[16:31], a[92:95], v[60:63], a[16:31]
    ds_read_b64_tr_b16 a[72:73], v12 offset:36864
    ds_read_b64_tr_b16 a[74:75], v12 offset:37888
    ds_read_b64_tr_b16 a[76:77], v13 offset:36864
    ds_read_b64_tr_b16 a[78:79], v13 offset:37888
    v_mfma_f32_32x32x16_bf16 a[32:47], a[96:99], v[60:63], a[32:47]
    s_add_u32 s61, s89, 384
    s_and_b32 s61, s61, 511
    s_add_u32 m0, s58, 49152
    s_mul_i32 s47, s61, s73
    buffer_load_dwordx4 v23, s[32:35], s47 offen lds
    v_mul_f32 v177, v177, v26
    v_mul_f32 v178, v178, v26
    v_mul_f32 v179, v179, v26
    v_mfma_f32_32x32x16_bf16 a[48:63], a[100:103], v[60:63], a[48:63]
    s_add_u32 m0, s58, 53248
    s_mul_i32 s48, s61, s74
    buffer_load_dwordx4 v24, s[36:39], s48 offen lds
    v_mul_f32 v180, v180, v26
    v_mul_f32 v181, v181, v26
    v_mul_f32 v182, v182, v26
    v_mul_f32 v183, v183, v26
    s_waitcnt lgkmcnt(0)
    v_mfma_f32_32x32x16_bf16 a[0:15], a[64:67], v[64:67], a[0:15]
    ds_read_b64_tr_b16 a[88:89], v10 offset:38912
    ds_read_b64_tr_b16 a[90:91], v10 offset:39936
    ds_read_b64_tr_b16 a[92:93], v11 offset:38912
    ds_read_b64_tr_b16 a[94:95], v11 offset:39936
    v_mfma_f32_32x32x16_bf16 a[16:31], a[68:71], v[64:67], a[16:31]
    ds_read_b64_tr_b16 a[96:97], v12 offset:38912
    ds_read_b64_tr_b16 a[98:99], v12 offset:39936
    ds_read_b64_tr_b16 a[100:101], v13 offset:38912
    ds_read_b64_tr_b16 a[102:103], v13 offset:39936
    v_mfma_f32_32x32x16_bf16 a[32:47], a[72:75], v[64:67], a[32:47]
    s_add_u32 s61, s89, 416
    s_and_b32 s61, s61, 511
    s_add_u32 m0, s58, 61440
    s_mul_i32 s47, s61, s73
    buffer_load_dwordx4 v23, s[32:35], s47 offen lds
    v_cvt_pk_bf16_f32 v184, v176, v177
    v_cvt_pk_bf16_f32 v185, v178, v179
    v_cvt_pk_bf16_f32 v186, v180, v181
    v_mfma_f32_32x32x16_bf16 a[48:63], a[76:79], v[64:67], a[48:63]
    s_add_u32 m0, s58, 65536
    s_mul_i32 s48, s61, s74
    buffer_load_dwordx4 v24, s[36:39], s48 offen lds
    v_cvt_pk_bf16_f32 v187, v182, v183
    s_add_u32 s62, s69, 1024
    buffer_store_dwordx4 v[184:187], v30, s[40:43], s62 offen sc1
    v_mul_f32 v192, v192, v200
    s_waitcnt lgkmcnt(0)
    v_mfma_f32_32x32x16_bf16 a[0:15], a[88:91], v[68:71], a[0:15]
    ds_read_b64_tr_b16 a[64:65], v10 offset:49152
    ds_read_b64_tr_b16 a[66:67], v10 offset:50176
    ds_read_b64_tr_b16 a[68:69], v11 offset:49152
    ds_read_b64_tr_b16 a[70:71], v11 offset:50176
    v_mfma_f32_32x32x16_bf16 a[16:31], a[92:95], v[68:71], a[16:31]
    ds_read_b64_tr_b16 a[72:73], v12 offset:49152
    ds_read_b64_tr_b16 a[74:75], v12 offset:50176
    ds_read_b64_tr_b16 a[76:77], v13 offset:49152
    ds_read_b64_tr_b16 a[78:79], v13 offset:50176
    v_mfma_f32_32x32x16_bf16 a[32:47], a[96:99], v[68:71], a[32:47]
    s_add_u32 s61, s89, 448
    s_and_b32 s61, s61, 511
    s_add_u32 m0, s58, 73728
    s_mul_i32 s47, s61, s73
    buffer_load_dwordx4 v23, s[32:35], s47 offen lds
    v_mul_f32 v193, v193, v201
    v_mul_f32 v194, v194, v202
    v_mul_f32 v195, v195, v203
    v_mfma_f32_32x32x16_bf16 a[48:63], a[100:103], v[68:71], a[48:63]
    s_add_u32 m0, s58, 77824
    s_mul_i32 s48, s61, s74
    buffer_load_dwordx4 v24, s[36:39], s48 offen lds
    v_mul_f32 v196, v196, v204
    v_mul_f32 v197, v197, v205
    v_mul_f32 v198, v198, v206
    v_mul_f32 v199, v199, v207
    s_waitcnt lgkmcnt(0)
    v_mfma_f32_32x32x16_bf16 a[0:15], a[64:67], v[72:75], a[0:15]
    ds_read_b64_tr_b16 a[88:89], v10 offset:51200
    ds_read_b64_tr_b16 a[90:91], v10 offset:52224
    ds_read_b64_tr_b16 a[92:93], v11 offset:51200
    ds_read_b64_tr_b16 a[94:95], v11 offset:52224
    v_mfma_f32_32x32x16_bf16 a[16:31], a[68:71], v[72:75], a[16:31]
    ds_read_b64_tr_b16 a[96:97], v12 offset:51200
    ds_read_b64_tr_b16 a[98:99], v12 offset:52224
    ds_read_b64_tr_b16 a[100:101], v13 offset:51200
    ds_read_b64_tr_b16 a[102:103], v13 offset:52224
    v_mfma_f32_32x32x16_bf16 a[32:47], a[72:75], v[72:75], a[32:47]
    s_add_u32 s61, s89, 480
    s_and_b32 s61, s61, 511
    s_add_u32 m0, s58, 86016
    s_mul_i32 s47, s61, s73
    buffer_load_dwordx4 v23, s[32:35], s47 offen lds
    v_mul_f32 v192, v192, v26
    v_mul_f32 v193, v193, v26
    v_mul_f32 v194, v194, v26
    v_mfma_f32_32x32x16_bf16 a[48:63], a[76:79], v[72:75], a[48:63]
    s_add_u32 m0, s58, 90112
    s_mul_i32 s48, s61, s74
    buffer_load_dwordx4 v24, s[36:39], s48 offen lds
    v_mul_f32 v195, v195, v26
    v_mul_f32 v196, v196, v26
    v_mul_f32 v197, v197, v26
    v_mul_f32 v198, v198, v26
    s_waitcnt lgkmcnt(0)
    v_mfma_f32_32x32x16_bf16 a[0:15], a[88:91], v[76:79], a[0:15]
    v_add_u32 v10, 61440, v10
    v_add_u32 v11, 61440, v11
    v_add_u32 v12, 61440, v12
    v_add_u32 v13, 61440, v13
    v_add_u32 v14, 61440, v14
    v_add_u32 v15, 61440, v15
    ds_read_b64_tr_b16 a[64:65], v10 offset:0
    ds_read_b64_tr_b16 a[66:67], v10 offset:1024
    ds_read_b64_tr_b16 a[68:69], v11 offset:0
    ds_read_b64_tr_b16 a[70:71], v11 offset:1024
    v_mfma_f32_32x32x16_bf16 a[16:31], a[92:95], v[76:79], a[16:31]
    ds_read_b64_tr_b16 a[72:73], v12 offset:0
    ds_read_b64_tr_b16 a[74:75], v12 offset:1024
    ds_read_b64_tr_b16 a[76:77], v13 offset:0
    ds_read_b64_tr_b16 a[78:79], v13 offset:1024
    v_mfma_f32_32x32x16_bf16 a[32:47], a[96:99], v[76:79], a[32:47]
    v_mul_f32_e64 v199, v199, v26
    v_cvt_pk_bf16_f32 v200, v192, v193
    v_cvt_pk_bf16_f32 v201, v194, v195
    v_mfma_f32_32x32x16_bf16 a[48:63], a[100:103], v[76:79], a[48:63]
    v_cvt_pk_bf16_f32 v202, v196, v197
    v_cvt_pk_bf16_f32 v203, v198, v199
    s_add_u32 s62, s69, 2048
    buffer_store_dwordx4 v[200:203], v30, s[40:43], s62 offen sc1
    s_waitcnt lgkmcnt(0)
    v_mfma_f32_32x32x16_bf16 a[0:15], a[64:67], v[80:83], a[0:15]
    ds_read_b64_tr_b16 a[88:89], v10 offset:2048
    ds_read_b64_tr_b16 a[90:91], v10 offset:3072
    ds_read_b64_tr_b16 a[92:93], v11 offset:2048
    ds_read_b64_tr_b16 a[94:95], v11 offset:3072
    v_mfma_f32_32x32x16_bf16 a[16:31], a[68:71], v[80:83], a[16:31]
    ds_read_b64_tr_b16 a[96:97], v12 offset:2048
    ds_read_b64_tr_b16 a[98:99], v12 offset:3072
    ds_read_b64_tr_b16 a[100:101], v13 offset:2048
    ds_read_b64_tr_b16 a[102:103], v13 offset:3072
    v_mfma_f32_32x32x16_bf16 a[32:47], a[72:75], v[80:83], a[32:47]
    v_mul_f32 v208, v208, v216
    v_mul_f32 v209, v209, v217
    v_mul_f32 v210, v210, v218
    v_mfma_f32_32x32x16_bf16 a[48:63], a[76:79], v[80:83], a[48:63]
    v_mul_f32 v211, v211, v219
    v_mul_f32 v212, v212, v220
    v_mul_f32 v213, v213, v221
    v_mul_f32_e64 v214, v214, v222
    s_waitcnt lgkmcnt(0)
    v_mfma_f32_32x32x16_bf16 a[0:15], a[88:91], v[84:87], a[0:15]
    ds_read_b64_tr_b16 a[64:65], v10 offset:12288
    ds_read_b64_tr_b16 a[66:67], v10 offset:13312
    ds_read_b64_tr_b16 a[68:69], v11 offset:12288
    ds_read_b64_tr_b16 a[70:71], v11 offset:13312
    v_mfma_f32_32x32x16_bf16 a[16:31], a[92:95], v[84:87], a[16:31]
    ds_read_b64_tr_b16 a[72:73], v12 offset:12288
    ds_read_b64_tr_b16 a[74:75], v12 offset:13312
    ds_read_b64_tr_b16 a[76:77], v13 offset:12288
    ds_read_b64_tr_b16 a[78:79], v13 offset:13312
    v_mfma_f32_32x32x16_bf16 a[32:47], a[96:99], v[84:87], a[32:47]
    v_mul_f32 v215, v215, v223
    v_mul_f32 v208, v208, v26
    v_mul_f32_e64 v209, v209, v26
    v_mfma_f32_32x32x16_bf16 a[48:63], a[100:103], v[84:87], a[48:63]
    v_mul_f32 v210, v210, v26
    v_mul_f32 v211, v211, v26
    v_mul_f32 v212, v212, v26
    v_mul_f32_e64 v213, v213, v26
    s_waitcnt lgkmcnt(0)
    v_mfma_f32_32x32x16_bf16 a[0:15], a[64:67], v[88:91], a[0:15]
    ds_read_b64_tr_b16 a[88:89], v10 offset:14336
    ds_read_b64_tr_b16 a[90:91], v10 offset:15360
    ds_read_b64_tr_b16 a[92:93], v11 offset:14336
    ds_read_b64_tr_b16 a[94:95], v11 offset:15360
    v_mfma_f32_32x32x16_bf16 a[16:31], a[68:71], v[88:91], a[16:31]
    ds_read_b64_tr_b16 a[96:97], v12 offset:14336
    ds_read_b64_tr_b16 a[98:99], v12 offset:15360
    ds_read_b64_tr_b16 a[100:101], v13 offset:14336
    ds_read_b64_tr_b16 a[102:103], v13 offset:15360
    v_mfma_f32_32x32x16_bf16 a[32:47], a[72:75], v[88:91], a[32:47]
    v_mul_f32 v214, v214, v26
    v_mul_f32 v215, v215, v26
    v_cvt_pk_bf16_f32 v216, v208, v209
    v_mfma_f32_32x32x16_bf16 a[48:63], a[76:79], v[88:91], a[48:63]
    v_cvt_pk_bf16_f32 v217, v210, v211
    v_cvt_pk_bf16_f32 v218, v212, v213
    v_cvt_pk_bf16_f32 v219, v214, v215
    s_add_u32 s62, s69, 3072
    s_waitcnt lgkmcnt(0)
    v_mfma_f32_32x32x16_bf16 a[0:15], a[88:91], v[92:95], a[0:15]
    s_waitcnt vmcnt(11)
    s_barrier
    v_add_u32 v10, 4294844416, v10
    v_add_u32 v11, 4294844416, v11
    v_add_u32 v12, 4294844416, v12
    v_add_u32 v13, 4294844416, v13
    v_add_u32 v14, 4294844416, v14
    v_add_u32 v15, 4294844416, v15
    ds_read_b64_tr_b16 a[64:65], v10 offset:0
    ds_read_b64_tr_b16 a[66:67], v10 offset:1024
    ds_read_b64_tr_b16 a[68:69], v11 offset:0
    ds_read_b64_tr_b16 a[70:71], v11 offset:1024
    v_mfma_f32_32x32x16_bf16 a[16:31], a[92:95], v[92:95], a[16:31]
    ds_read_b64_tr_b16 a[72:73], v12 offset:0
    ds_read_b64_tr_b16 a[74:75], v12 offset:1024
    ds_read_b64_tr_b16 a[76:77], v13 offset:0
    ds_read_b64_tr_b16 a[78:79], v13 offset:1024
    v_mfma_f32_32x32x16_bf16 a[32:47], a[96:99], v[92:95], a[32:47]
    buffer_store_dwordx4 v[216:219], v30, s[40:43], s62 offen sc1
    s_add_u32 s65, s85, 0
    s_lshr_b32 s62, s65, 3
    v_mfma_f32_32x32x16_bf16 a[48:63], a[100:103], v[92:95], a[48:63]
    s_and_b32 s63, s65, 7
    s_lshl_b32 s63, s63, 18
    s_lshl_b32 s64, s62, 21
    s_add_u32 s63, s63, s64
    s_waitcnt lgkmcnt(0)
    v_mfma_f32_32x32x16_bf16 a[0:15], a[64:67], v[96:99], a[0:15]
    ds_read_b64_tr_b16 a[88:89], v10 offset:2048
    ds_read_b64_tr_b16 a[90:91], v10 offset:3072
    ds_read_b64_tr_b16 a[92:93], v11 offset:2048
    ds_read_b64_tr_b16 a[94:95], v11 offset:3072
    v_mfma_f32_32x32x16_bf16 a[16:31], a[68:71], v[96:99], a[16:31]
    ds_read_b64_tr_b16 a[96:97], v12 offset:2048
    ds_read_b64_tr_b16 a[98:99], v12 offset:3072
    ds_read_b64_tr_b16 a[100:101], v13 offset:2048
    ds_read_b64_tr_b16 a[102:103], v13 offset:3072
    v_mfma_f32_32x32x16_bf16 a[32:47], a[72:75], v[96:99], a[32:47]
    s_add_u32 s86, s63, s83
    s_cmp_eq_u32 s62, 0
    s_cselect_b32 s82, 0x3eb8aa3b, 1.0
    s_cmp_eq_u32 s62, 2
    s_cselect_b64 s[80:81], -1, 0
    v_mfma_f32_32x32x16_bf16 a[48:63], a[76:79], v[96:99], a[48:63]
    v_mul_f32_e64 v18, s82, v25
    v_cndmask_b32 v17, v30, v31, s[80:81]
    v_mul_f32 v224, v224, v18
    v_mul_f32_e64 v225, v225, v18
    s_waitcnt lgkmcnt(0)
    v_mfma_f32_32x32x16_bf16 a[0:15], a[88:91], v[100:103], a[0:15]
    ds_read_b64_tr_b16 a[64:65], v10 offset:12288
    ds_read_b64_tr_b16 a[66:67], v10 offset:13312
    ds_read_b64_tr_b16 a[68:69], v11 offset:12288
    ds_read_b64_tr_b16 a[70:71], v11 offset:13312
    v_mfma_f32_32x32x16_bf16 a[16:31], a[92:95], v[100:103], a[16:31]
    ds_read_b64_tr_b16 a[72:73], v12 offset:12288
    ds_read_b64_tr_b16 a[74:75], v12 offset:13312
    ds_read_b64_tr_b16 a[76:77], v13 offset:12288
    ds_read_b64_tr_b16 a[78:79], v13 offset:13312
    v_mfma_f32_32x32x16_bf16 a[32:47], a[96:99], v[100:103], a[32:47]
    v_mul_f32 v226, v226, v18
    v_mul_f32 v227, v227, v18
    v_mul_f32_e64 v228, v228, v18
    v_mfma_f32_32x32x16_bf16 a[48:63], a[100:103], v[100:103], a[48:63]
    v_mul_f32 v229, v229, v18
    v_mul_f32 v230, v230, v18
    v_mul_f32 v231, v231, v18
    v_mul_f32_e64 v232, v232, v18
    s_waitcnt lgkmcnt(0)
    v_mfma_f32_32x32x16_bf16 a[0:15], a[64:67], v[104:107], a[0:15]
    ds_read_b64_tr_b16 a[88:89], v10 offset:14336
    ds_read_b64_tr_b16 a[90:91], v10 offset:15360
    ds_read_b64_tr_b16 a[92:93], v11 offset:14336
    ds_read_b64_tr_b16 a[94:95], v11 offset:15360
    v_mfma_f32_32x32x16_bf16 a[16:31], a[68:71], v[104:107], a[16:31]
    ds_read_b64_tr_b16 a[96:97], v12 offset:14336
    ds_read_b64_tr_b16 a[98:99], v12 offset:15360
    ds_read_b64_tr_b16 a[100:101], v13 offset:14336
    ds_read_b64_tr_b16 a[102:103], v13 offset:15360
    v_mfma_f32_32x32x16_bf16 a[32:47], a[72:75], v[104:107], a[32:47]
    v_mul_f32 v233, v233, v18
    v_mul_f32 v234, v234, v18
    v_mul_f32_e64 v235, v235, v18
    v_mfma_f32_32x32x16_bf16 a[48:63], a[76:79], v[104:107], a[48:63]
    v_mul_f32 v236, v236, v18
    v_mul_f32 v237, v237, v18
    v_mul_f32 v238, v238, v18
    v_mul_f32_e64 v239, v239, v18
    s_waitcnt lgkmcnt(0)
    v_mfma_f32_32x32x16_bf16 a[0:15], a[88:91], v[108:111], a[0:15]
    ds_read_b64_tr_b16 a[64:65], v10 offset:24576
    ds_read_b64_tr_b16 a[66:67], v10 offset:25600
    ds_read_b64_tr_b16 a[68:69], v11 offset:24576
    ds_read_b64_tr_b16 a[70:71], v11 offset:25600
    v_mfma_f32_32x32x16_bf16 a[16:31], a[92:95], v[108:111], a[16:31]
    ds_read_b64_tr_b16 a[72:73], v12 offset:24576
    ds_read_b64_tr_b16 a[74:75], v12 offset:25600
    ds_read_b64_tr_b16 a[76:77], v13 offset:24576
    ds_read_b64_tr_b16 a[78:79], v13 offset:25600
    v_mfma_f32_32x32x16_bf16 a[32:47], a[96:99], v[108:111], a[32:47]
    v_cvt_pk_bf16_f32 v224, v224, v225
    v_cvt_pk_bf16_f32 v225, v226, v227
    v_cvt_pk_bf16_f32 v226, v228, v229
    v_mfma_f32_32x32x16_bf16 a[48:63], a[100:103], v[108:111], a[48:63]
    v_cvt_pk_bf16_f32 v227, v230, v231
    s_add_u32 s63, s86, 0
    s_add_u32 s64, s86, 65536
    v_cvt_pk_bf16_f32 v228, v232, v233
    s_waitcnt lgkmcnt(0)
    v_mfma_f32_32x32x16_bf16 a[0:15], a[64:67], v[112:115], a[0:15]
    ds_read_b64_tr_b16 a[88:89], v10 offset:26624
    ds_read_b64_tr_b16 a[90:91], v10 offset:27648
    ds_read_b64_tr_b16 a[92:93], v11 offset:26624
    ds_read_b64_tr_b16 a[94:95], v11 offset:27648
    v_mfma_f32_32x32x16_bf16 a[16:31], a[68:71], v[112:115], a[16:31]
    ds_read_b64_tr_b16 a[96:97], v12 offset:26624
    ds_read_b64_tr_b16 a[98:99], v12 offset:27648
    ds_read_b64_tr_b16 a[100:101], v13 offset:26624
    ds_read_b64_tr_b16 a[102:103], v13 offset:27648
    v_mfma_f32_32x32x16_bf16 a[32:47], a[72:75], v[112:115], a[32:47]
    v_cvt_pk_bf16_f32 v229, v234, v235
    v_cvt_pk_bf16_f32 v230, v236, v237
    v_cvt_pk_bf16_f32 v231, v238, v239
    v_mfma_f32_32x32x16_bf16 a[48:63], a[76:79], v[112:115], a[48:63]
    v_mov_b32 v232, 0
    v_mov_b32 v233, 0
    buffer_store_dwordx4 v[224:227], v17, s[40:43], s63 offen sc1
    buffer_store_dwordx4 v[228:231], v17, s[40:43], s64 offen sc1
    s_waitcnt lgkmcnt(0)
    v_mfma_f32_32x32x16_bf16 a[0:15], a[88:91], v[116:119], a[0:15]
    ds_read_b64_tr_b16 a[64:65], v10 offset:36864
    ds_read_b64_tr_b16 a[66:67], v10 offset:37888
    ds_read_b64_tr_b16 a[68:69], v11 offset:36864
    ds_read_b64_tr_b16 a[70:71], v11 offset:37888
    v_mfma_f32_32x32x16_bf16 a[16:31], a[92:95], v[116:119], a[16:31]
    ds_read_b64_tr_b16 a[72:73], v12 offset:36864
    ds_read_b64_tr_b16 a[74:75], v12 offset:37888
    ds_read_b64_tr_b16 a[76:77], v13 offset:36864
    ds_read_b64_tr_b16 a[78:79], v13 offset:37888
    v_mfma_f32_32x32x16_bf16 a[32:47], a[96:99], v[116:119], a[32:47]
    v_dot2c_f32_bf16 v232, v224, v224
    v_dot2c_f32_bf16 v233, v228, v228
    v_dot2c_f32_bf16 v232, v225, v225
    v_mfma_f32_32x32x16_bf16 a[48:63], a[100:103], v[116:119], a[48:63]
    v_dot2c_f32_bf16 v233, v229, v229
    v_dot2c_f32_bf16 v232, v226, v226
    v_dot2c_f32_bf16 v233, v230, v230
    v_dot2c_f32_bf16 v232, v227, v227
    s_waitcnt lgkmcnt(0)
    v_mfma_f32_32x32x16_bf16 a[0:15], a[64:67], v[120:123], a[0:15]
    ds_read_b64_tr_b16 a[88:89], v10 offset:38912
    ds_read_b64_tr_b16 a[90:91], v10 offset:39936
    ds_read_b64_tr_b16 a[92:93], v11 offset:38912
    ds_read_b64_tr_b16 a[94:95], v11 offset:39936
    v_mfma_f32_32x32x16_bf16 a[16:31], a[68:71], v[120:123], a[16:31]
    ds_read_b64_tr_b16 a[96:97], v12 offset:38912
    ds_read_b64_tr_b16 a[98:99], v12 offset:39936
    ds_read_b64_tr_b16 a[100:101], v13 offset:38912
    ds_read_b64_tr_b16 a[102:103], v13 offset:39936
    v_mfma_f32_32x32x16_bf16 a[32:47], a[72:75], v[120:123], a[32:47]
    v_dot2c_f32_bf16 v233, v231, v231
    v_mul_f32 v240, v240, v18
    v_mul_f32 v241, v241, v18
    v_mfma_f32_32x32x16_bf16 a[48:63], a[76:79], v[120:123], a[48:63]
    v_mul_f32 v242, v242, v18
    v_mul_f32 v243, v243, v18
    v_max3_f32 v28, v232, v233, v28
    v_mul_f32 v244, v244, v18
    s_waitcnt lgkmcnt(0)
    v_mfma_f32_32x32x16_bf16 a[0:15], a[88:91], v[124:127], a[0:15]
    s_waitcnt vmcnt(4)
    s_barrier
    ds_read_b64_tr_b16 a[64:65], v10 offset:49152
    ds_read_b64_tr_b16 a[66:67], v10 offset:50176
    ds_read_b64_tr_b16 a[68:69], v11 offset:49152
    ds_read_b64_tr_b16 a[70:71], v11 offset:50176
    v_mfma_f32_32x32x16_bf16 a[16:31], a[92:95], v[124:127], a[16:31]
    ds_read_b64_tr_b16 a[72:73], v12 offset:49152
    ds_read_b64_tr_b16 a[74:75], v12 offset:50176
    ds_read_b64_tr_b16 a[76:77], v13 offset:49152
    ds_read_b64_tr_b16 a[78:79], v13 offset:50176
    v_mfma_f32_32x32x16_bf16 a[32:47], a[96:99], v[124:127], a[32:47]
    v_mul_f32 v245, v245, v18
    v_mul_f32 v246, v246, v18
    v_mul_f32_e64 v247, v247, v18
    v_mfma_f32_32x32x16_bf16 a[48:63], a[100:103], v[124:127], a[48:63]
    v_mul_f32 v248, v248, v18
    v_mul_f32 v249, v249, v18
    v_mul_f32 v250, v250, v18
    v_mul_f32_e64 v251, v251, v18
    s_waitcnt lgkmcnt(0)
    v_mfma_f32_32x32x16_bf16 a[0:15], a[64:67], v[128:131], a[0:15]
    ds_read_b64_tr_b16 a[88:89], v10 offset:51200
    ds_read_b64_tr_b16 a[90:91], v10 offset:52224
    ds_read_b64_tr_b16 a[92:93], v11 offset:51200
    ds_read_b64_tr_b16 a[94:95], v11 offset:52224
    v_mfma_f32_32x32x16_bf16 a[16:31], a[68:71], v[128:131], a[16:31]
    ds_read_b64_tr_b16 a[96:97], v12 offset:51200
    ds_read_b64_tr_b16 a[98:99], v12 offset:52224
    ds_read_b64_tr_b16 a[100:101], v13 offset:51200
    ds_read_b64_tr_b16 a[102:103], v13 offset:52224
    v_mfma_f32_32x32x16_bf16 a[32:47], a[72:75], v[128:131], a[32:47]
    v_mul_f32 v252, v252, v18
    v_mul_f32 v253, v253, v18
    v_mul_f32_e64 v254, v254, v18
    v_mfma_f32_32x32x16_bf16 a[48:63], a[76:79], v[128:131], a[48:63]
    v_mul_f32_e64 v255, v255, v18
    v_cvt_pk_bf16_f32 v240, v240, v241
    v_cvt_pk_bf16_f32 v241, v242, v243
    v_cvt_pk_bf16_f32 v242, v244, v245
    s_waitcnt lgkmcnt(0)
    v_mfma_f32_32x32x16_bf16 a[0:15], a[88:91], v[132:135], a[0:15]
    v_add_u32 v10, 61440, v10
    v_add_u32 v11, 61440, v11
    v_add_u32 v12, 61440, v12
    v_add_u32 v13, 61440, v13
    v_add_u32 v14, 61440, v14
    v_add_u32 v15, 61440, v15
    ds_read_b64_tr_b16 a[64:65], v10 offset:0
    ds_read_b64_tr_b16 a[66:67], v10 offset:1024
    ds_read_b64_tr_b16 a[68:69], v11 offset:0
    ds_read_b64_tr_b16 a[70:71], v11 offset:1024
    v_mfma_f32_32x32x16_bf16 a[16:31], a[92:95], v[132:135], a[16:31]
    ds_read_b64_tr_b16 a[72:73], v12 offset:0
    ds_read_b64_tr_b16 a[74:75], v12 offset:1024
    ds_read_b64_tr_b16 a[76:77], v13 offset:0
    ds_read_b64_tr_b16 a[78:79], v13 offset:1024
    v_mfma_f32_32x32x16_bf16 a[32:47], a[96:99], v[132:135], a[32:47]
    v_cvt_pk_bf16_f32 v243, v246, v247
    s_add_u32 s63, s86, 131072
    s_add_u32 s64, s86, 196608
    v_mfma_f32_32x32x16_bf16 a[48:63], a[100:103], v[132:135], a[48:63]
    v_cvt_pk_bf16_f32 v244, v248, v249
    v_cvt_pk_bf16_f32 v245, v250, v251
    v_cvt_pk_bf16_f32 v246, v252, v253
    v_cvt_pk_bf16_f32 v247, v254, v255
    s_waitcnt lgkmcnt(0)
    v_mfma_f32_32x32x16_bf16 a[0:15], a[64:67], v[136:139], a[0:15]
    ds_read_b64_tr_b16 a[88:89], v10 offset:2048
    ds_read_b64_tr_b16 a[90:91], v10 offset:3072
    ds_read_b64_tr_b16 a[92:93], v11 offset:2048
    ds_read_b64_tr_b16 a[94:95], v11 offset:3072
    v_mfma_f32_32x32x16_bf16 a[16:31], a[68:71], v[136:139], a[16:31]
    ds_read_b64_tr_b16 a[96:97], v12 offset:2048
    ds_read_b64_tr_b16 a[98:99], v12 offset:3072
    ds_read_b64_tr_b16 a[100:101], v13 offset:2048
    ds_read_b64_tr_b16 a[102:103], v13 offset:3072
    v_mfma_f32_32x32x16_bf16 a[32:47], a[72:75], v[136:139], a[32:47]
    v_mov_b32 v248, 0
    v_mov_b32 v249, 0
    buffer_store_dwordx4 v[240:243], v17, s[40:43], s63 offen sc1
    v_mfma_f32_32x32x16_bf16 a[48:63], a[76:79], v[136:139], a[48:63]
    buffer_store_dwordx4 v[244:247], v17, s[40:43], s64 offen sc1
    v_dot2c_f32_bf16 v248, v240, v240
    v_dot2c_f32_bf16 v249, v244, v244
    v_dot2c_f32_bf16 v248, v241, v241
    s_waitcnt lgkmcnt(0)
    v_mfma_f32_32x32x16_bf16 a[0:15], a[88:91], v[140:143], a[0:15]
    ds_read_b64_tr_b16 a[64:65], v10 offset:12288
    ds_read_b64_tr_b16 a[66:67], v10 offset:13312
    ds_read_b64_tr_b16 a[68:69], v11 offset:12288
    ds_read_b64_tr_b16 a[70:71], v11 offset:13312
    v_mfma_f32_32x32x16_bf16 a[16:31], a[92:95], v[140:143], a[16:31]
    ds_read_b64_tr_b16 a[72:73], v12 offset:12288
    ds_read_b64_tr_b16 a[74:75], v12 offset:13312
    ds_read_b64_tr_b16 a[76:77], v13 offset:12288
    ds_read_b64_tr_b16 a[78:79], v13 offset:13312
    v_mfma_f32_32x32x16_bf16 a[32:47], a[96:99], v[140:143], a[32:47]
    v_dot2c_f32_bf16 v249, v245, v245
    v_dot2c_f32_bf16 v248, v242, v242
    v_dot2c_f32_bf16 v249, v246, v246
    v_mfma_f32_32x32x16_bf16 a[48:63], a[100:103], v[140:143], a[48:63]
    v_dot2c_f32_bf16 v248, v243, v243
    v_dot2c_f32_bf16 v249, v247, v247
    s_nop 2
    v_max3_f32 v28, v248, v249, v28
    s_waitcnt lgkmcnt(0)
    v_mfma_f32_32x32x16_bf16 a[0:15], a[64:67], v[144:147], a[0:15]
    ds_read_b64_tr_b16 a[88:89], v10 offset:14336
    ds_read_b64_tr_b16 a[90:91], v10 offset:15360
    ds_read_b64_tr_b16 a[92:93], v11 offset:14336
    ds_read_b64_tr_b16 a[94:95], v11 offset:15360
    v_mfma_f32_32x32x16_bf16 a[16:31], a[68:71], v[144:147], a[16:31]
    ds_read_b64_tr_b16 a[96:97], v12 offset:14336
    ds_read_b64_tr_b16 a[98:99], v12 offset:15360
    ds_read_b64_tr_b16 a[100:101], v13 offset:14336
    ds_read_b64_tr_b16 a[102:103], v13 offset:15360
    v_mfma_f32_32x32x16_bf16 a[32:47], a[72:75], v[144:147], a[32:47]
    v_mfma_f32_32x32x16_bf16 a[48:63], a[76:79], v[144:147], a[48:63]
    s_waitcnt lgkmcnt(0)
    v_mfma_f32_32x32x16_bf16 a[0:15], a[88:91], v[148:151], a[0:15]
    ds_read_b64_tr_b16 a[64:65], v10 offset:24576
    ds_read_b64_tr_b16 a[66:67], v10 offset:25600
    ds_read_b64_tr_b16 a[68:69], v11 offset:24576
    ds_read_b64_tr_b16 a[70:71], v11 offset:25600
    v_mfma_f32_32x32x16_bf16 a[16:31], a[92:95], v[148:151], a[16:31]
    ds_read_b64_tr_b16 a[72:73], v12 offset:24576
    ds_read_b64_tr_b16 a[74:75], v12 offset:25600
    ds_read_b64_tr_b16 a[76:77], v13 offset:24576
    ds_read_b64_tr_b16 a[78:79], v13 offset:25600
    v_mfma_f32_32x32x16_bf16 a[32:47], a[96:99], v[148:151], a[32:47]
    v_mfma_f32_32x32x16_bf16 a[48:63], a[100:103], v[148:151], a[48:63]
    s_waitcnt lgkmcnt(0)
    v_mfma_f32_32x32x16_bf16 a[0:15], a[64:67], v[152:155], a[0:15]
    ds_read_b64_tr_b16 a[88:89], v10 offset:26624
    ds_read_b64_tr_b16 a[90:91], v10 offset:27648
    ds_read_b64_tr_b16 a[92:93], v11 offset:26624
    ds_read_b64_tr_b16 a[94:95], v11 offset:27648
    v_mfma_f32_32x32x16_bf16 a[16:31], a[68:71], v[152:155], a[16:31]
    ds_read_b64_tr_b16 a[96:97], v12 offset:26624
    ds_read_b64_tr_b16 a[98:99], v12 offset:27648
    ds_read_b64_tr_b16 a[100:101], v13 offset:26624
    ds_read_b64_tr_b16 a[102:103], v13 offset:27648
    v_mfma_f32_32x32x16_bf16 a[32:47], a[72:75], v[152:155], a[32:47]
    v_mfma_f32_32x32x16_bf16 a[48:63], a[76:79], v[152:155], a[48:63]
    s_waitcnt lgkmcnt(0)
    v_mfma_f32_32x32x16_bf16 a[0:15], a[88:91], v[156:159], a[0:15]
    v_mfma_f32_32x32x16_bf16 a[16:31], a[92:95], v[156:159], a[16:31]
    v_mfma_f32_32x32x16_bf16 a[32:47], a[96:99], v[156:159], a[32:47]
    v_mfma_f32_32x32x16_bf16 a[48:63], a[100:103], v[156:159], a[48:63]
    s_nop 8
    v_accvgpr_read_b32 v32, a0
    v_accvgpr_read_b32 v33, a1
    v_accvgpr_read_b32 v34, a2
    v_accvgpr_read_b32 v35, a3
    v_accvgpr_read_b32 v36, a4
    v_accvgpr_read_b32 v37, a5
    v_accvgpr_read_b32 v38, a6
    v_accvgpr_read_b32 v39, a7
    v_accvgpr_read_b32 v40, a8
    v_accvgpr_read_b32 v41, a9
    v_accvgpr_read_b32 v42, a10
    v_accvgpr_read_b32 v43, a11
    v_accvgpr_read_b32 v44, a12
    v_accvgpr_read_b32 v45, a13
    v_accvgpr_read_b32 v46, a14
    v_accvgpr_read_b32 v47, a15
    v_accvgpr_read_b32 v48, a16
    v_accvgpr_read_b32 v49, a17
    v_accvgpr_read_b32 v50, a18
    v_accvgpr_read_b32 v51, a19
    v_accvgpr_read_b32 v52, a20
    v_accvgpr_read_b32 v53, a21
    v_accvgpr_read_b32 v54, a22
    v_accvgpr_read_b32 v55, a23
    v_accvgpr_read_b32 v56, a24
    v_accvgpr_read_b32 v57, a25
    v_accvgpr_read_b32 v58, a26
    v_accvgpr_read_b32 v59, a27
    v_accvgpr_read_b32 v60, a28
    v_accvgpr_read_b32 v61, a29
    v_accvgpr_read_b32 v62, a30
    v_accvgpr_read_b32 v63, a31
    v_accvgpr_read_b32 v64, a32
    v_accvgpr_read_b32 v65, a33
    v_accvgpr_read_b32 v66, a34
    v_accvgpr_read_b32 v67, a35
    v_accvgpr_read_b32 v68, a36
    v_accvgpr_read_b32 v69, a37
    v_accvgpr_read_b32 v70, a38
    v_accvgpr_read_b32 v71, a39
    v_accvgpr_read_b32 v72, a40
    v_accvgpr_read_b32 v73, a41
    v_accvgpr_read_b32 v74, a42
    v_accvgpr_read_b32 v75, a43
    v_accvgpr_read_b32 v76, a44
    v_accvgpr_read_b32 v77, a45
    v_accvgpr_read_b32 v78, a46
    v_accvgpr_read_b32 v79, a47
    v_accvgpr_read_b32 v80, a48
    v_accvgpr_read_b32 v81, a49
    v_accvgpr_read_b32 v82, a50
    v_accvgpr_read_b32 v83, a51
    v_accvgpr_read_b32 v84, a52
    v_accvgpr_read_b32 v85, a53
    v_accvgpr_read_b32 v86, a54
    v_accvgpr_read_b32 v87, a55
    v_accvgpr_read_b32 v88, a56
    v_accvgpr_read_b32 v89, a57
    v_accvgpr_read_b32 v90, a58
    v_accvgpr_read_b32 v91, a59
    v_accvgpr_read_b32 v92, a60
    v_accvgpr_read_b32 v93, a61
    v_accvgpr_read_b32 v94, a62
    v_accvgpr_read_b32 v95, a63
    v_mov_b32 v27, v26
    v_pk_mul_f32 v[32:33], v[32:33], v[40:41]
    v_pk_mul_f32 v[34:35], v[34:35], v[42:43]
    v_pk_mul_f32 v[36:37], v[36:37], v[44:45]
    v_pk_mul_f32 v[38:39], v[38:39], v[46:47]
    v_pk_mul_f32 v[32:33], v[32:33], v[26:27]
    v_pk_mul_f32 v[34:35], v[34:35], v[26:27]
    v_pk_mul_f32 v[36:37], v[36:37], v[26:27]
    v_pk_mul_f32 v[38:39], v[38:39], v[26:27]
    v_cvt_pk_bf16_f32 v40, v32, v33
    v_cvt_pk_bf16_f32 v41, v34, v35
    v_cvt_pk_bf16_f32 v42, v36, v37
    v_cvt_pk_bf16_f32 v43, v38, v39
    s_add_u32 s62, s69, 4096
    buffer_store_dwordx4 v[40:43], v30, s[40:43], s62 offen sc1
    v_pk_mul_f32 v[48:49], v[48:49], v[56:57]
    v_pk_mul_f32 v[50:51], v[50:51], v[58:59]
    v_pk_mul_f32 v[52:53], v[52:53], v[60:61]
    v_pk_mul_f32 v[54:55], v[54:55], v[62:63]
    v_pk_mul_f32 v[48:49], v[48:49], v[26:27]
    v_pk_mul_f32 v[50:51], v[50:51], v[26:27]
    v_pk_mul_f32 v[52:53], v[52:53], v[26:27]
    v_pk_mul_f32 v[54:55], v[54:55], v[26:27]
    v_cvt_pk_bf16_f32 v56, v48, v49
    v_cvt_pk_bf16_f32 v57, v50, v51
    v_cvt_pk_bf16_f32 v58, v52, v53
    v_cvt_pk_bf16_f32 v59, v54, v55
    s_add_u32 s62, s69, 5120
    buffer_store_dwordx4 v[56:59], v30, s[40:43], s62 offen sc1
    v_pk_mul_f32 v[64:65], v[64:65], v[72:73]
    v_pk_mul_f32 v[66:67], v[66:67], v[74:75]
    v_pk_mul_f32 v[68:69], v[68:69], v[76:77]
    v_pk_mul_f32 v[70:71], v[70:71], v[78:79]
    v_pk_mul_f32 v[64:65], v[64:65], v[26:27]
    v_pk_mul_f32 v[66:67], v[66:67], v[26:27]
    v_pk_mul_f32 v[68:69], v[68:69], v[26:27]
    v_pk_mul_f32 v[70:71], v[70:71], v[26:27]
    v_cvt_pk_bf16_f32 v72, v64, v65
    v_cvt_pk_bf16_f32 v73, v66, v67
    v_cvt_pk_bf16_f32 v74, v68, v69
    v_cvt_pk_bf16_f32 v75, v70, v71
    s_add_u32 s62, s69, 6144
    buffer_store_dwordx4 v[72:75], v30, s[40:43], s62 offen sc1
    v_pk_mul_f32 v[80:81], v[80:81], v[88:89]
    v_pk_mul_f32 v[82:83], v[82:83], v[90:91]
    v_pk_mul_f32 v[84:85], v[84:85], v[92:93]
    v_pk_mul_f32 v[86:87], v[86:87], v[94:95]
    v_pk_mul_f32 v[80:81], v[80:81], v[26:27]
    v_pk_mul_f32 v[82:83], v[82:83], v[26:27]
    v_pk_mul_f32 v[84:85], v[84:85], v[26:27]
    v_pk_mul_f32 v[86:87], v[86:87], v[26:27]
    v_cvt_pk_bf16_f32 v88, v80, v81
    v_cvt_pk_bf16_f32 v89, v82, v83
    v_cvt_pk_bf16_f32 v90, v84, v85
    v_cvt_pk_bf16_f32 v91, v86, v87
    s_add_u32 s62, s69, 7168
    buffer_store_dwordx4 v[88:91], v30, s[40:43], s62 offen sc1
    s_branch .Lk1_epi_done
.Lk1_p2B:
    .p2align 3
    s_waitcnt lgkmcnt(0)
    v_mfma_f32_32x32x16_bf16 a[0:15], a[64:67], v[32:35], 0
    ds_read_b64_tr_b16 a[88:89], v10 offset:51200
    ds_read_b64_tr_b16 a[90:91], v10 offset:52224
    ds_read_b64_tr_b16 a[92:93], v11 offset:51200
    ds_read_b64_tr_b16 a[94:95], v11 offset:52224
    v_mfma_f32_32x32x16_bf16 a[16:31], a[68:71], v[32:35], 0
    ds_read_b64_tr_b16 a[96:97], v12 offset:51200
    ds_read_b64_tr_b16 a[98:99], v12 offset:52224
    ds_read_b64_tr_b16 a[100:101], v13 offset:51200
    ds_read_b64_tr_b16 a[102:103], v13 offset:52224
    v_mfma_f32_32x32x16_bf16 a[32:47], a[72:75], v[32:35], 0
    s_add_u32 s61, s89, 288
    s_and_b32 s61, s61, 511
    s_add_u32 m0, s58, 12288
    s_mul_i32 s47, s61, s73
    buffer_load_dwordx4 v23, s[32:35], s47 offen lds
    v_mfma_f32_32x32x16_bf16 a[48:63], a[76:79], v[32:35], 0
    s_add_u32 m0, s58, 16384
    s_mul_i32 s48, s61, s74
    buffer_load_dwordx4 v24, s[36:39], s48 offen lds
    s_waitcnt lgkmcnt(0)
    v_mfma_f32_32x32x16_bf16 a[0:15], a[88:91], v[36:39], a[0:15]
    v_add_u32 v10, 61440, v10
    v_add_u32 v11, 61440, v11
    v_add_u32 v12, 61440, v12
    v_add_u32 v13, 61440, v13
    v_add_u32 v14, 61440, v14
    v_add_u32 v15, 61440, v15
    ds_read_b64_tr_b16 a[64:65], v10 offset:0
    ds_read_b64_tr_b16 a[66:67], v10 offset:1024
    ds_read_b64_tr_b16 a[68:69], v11 offset:0
    ds_read_b64_tr_b16 a[70:71], v11 offset:1024
    v_mfma_f32_32x32x16_bf16 a[16:31], a[92:95], v[36:39], a[16:31]
    ds_read_b64_tr_b16 a[72:73], v12 offset:0
    ds_read_b64_tr_b16 a[74:75], v12 offset:1024
    ds_read_b64_tr_b16 a[76:77], v13 offset:0
    ds_read_b64_tr_b16 a[78:79], v13 offset:1024
    v_mfma_f32_32x32x16_bf16 a[32:47], a[96:99], v[36:39], a[32:47]
    s_add_u32 s61, s89, 320
    s_and_b32 s61, s61, 511
    s_add_u32 m0, s58, 24576
    s_mul_i32 s47, s61, s73
    buffer_load_dwordx4 v23, s[32:35], s47 offen lds
    v_mov_b32 v4, -1
    v_mov_b32 v5, -1
    v_mov_b32 v6, -1
    v_mov_b32 v7, -1
    s_lshl_b32 s84, s2, 13
    v_mfma_f32_32x32x16_bf16 a[48:63], a[100:103], v[36:39], a[48:63]
    s_add_u32 m0, s58, 28672
    s_mul_i32 s48, s61, s74
    buffer_load_dwordx4 v24, s[36:39], s48 offen lds
    s_lshl_b32 s63, s54, 11
    s_add_u32 s84, s84, s63
    s_add_u32 s84, s84, 14680064
    buffer_store_dwordx4 v[4:7], v30, s[40:43], s84 offen sc1
    buffer_store_dwordx4 v[4:7], v30, s[40:43], s84 offen offset:1024 sc1
    s_waitcnt lgkmcnt(0)
    v_mfma_f32_32x32x16_bf16 a[0:15], a[64:67], v[40:43], a[0:15]
    ds_read_b64_tr_b16 a[88:89], v10 offset:2048
    ds_read_b64_tr_b16 a[90:91], v10 offset:3072
    ds_read_b64_tr_b16 a[92:93], v11 offset:2048
    ds_read_b64_tr_b16 a[94:95], v11 offset:3072
    v_mfma_f32_32x32x16_bf16 a[16:31], a[68:71], v[40:43], a[16:31]
    ds_read_b64_tr_b16 a[96:97], v12 offset:2048
    ds_read_b64_tr_b16 a[98:99], v12 offset:3072
    ds_read_b64_tr_b16 a[100:101], v13 offset:2048
    ds_read_b64_tr_b16 a[102:103], v13 offset:3072
    v_mfma_f32_32x32x16_bf16 a[32:47], a[72:75], v[40:43], a[32:47]
    s_add_u32 s61, s89, 352
    s_and_b32 s61, s61, 511
    s_add_u32 m0, s58, 36864
    s_mul_i32 s47, s61, s73
    buffer_load_dwordx4 v23, s[32:35], s47 offen lds
    s_add_u32 s65, s85, 0
    s_lshr_b32 s62, s65, 3
    s_and_b32 s63, s65, 7
    s_lshl_b32 s63, s63, 18
    s_lshl_b32 s64, s62, 21
    v_mfma_f32_32x32x16_bf16 a[48:63], a[76:79], v[40:43], a[48:63]
    s_add_u32 m0, s58, 40960
    s_mul_i32 s48, s61, s74
    buffer_load_dwordx4 v24, s[36:39], s48 offen lds
    s_add_u32 s63, s63, s64
    s_add_u32 s86, s63, s83
    s_cmp_eq_u32 s62, 0
    s_cselect_b32 s82, 0x3eb8aa3b, 1.0
    s_cmp_eq_u32 s62, 2
    s_cselect_b64 s[80:81], -1, 0
    v_mul_f32 v18, s82, v25
    s_waitcnt lgkmcnt(0)
    v_mfma_f32_32x32x16_bf16 a[0:15], a[88:91], v[44:47], a[0:15]
    ds_read_b64_tr_b16 a[64:65], v10 offset:12288
    ds_read_b64_tr_b16 a[66:67], v10 offset:13312
    ds_read_b64_tr_b16 a[68:69], v11 offset:12288
    ds_read_b64_tr_b16 a[70:71], v11 offset:13312
    v_mfma_f32_32x32x16_bf16 a[16:31], a[92:95], v[44:47], a[16:31]
    ds_read_b64_tr_b16 a[72:73], v12 offset:12288
    ds_read_b64_tr_b16 a[74:75], v12 offset:13312
    ds_read_b64_tr_b16 a[76:77], v13 offset:12288
    ds_read_b64_tr_b16 a[78:79], v13 offset:13312
    v_mfma_f32_32x32x16_bf16 a[32:47], a[96:99], v[44:47], a[32:47]
    v_cndmask_b32 v17, v30, v31, s[80:81]
    v_mul_f32 v160, v160, v18
    v_mul_f32 v161, v161, v18
    v_mul_f32 v162, v162, v18
    v_mul_f32 v163, v163, v18
    v_mfma_f32_32x32x16_bf16 a[48:63], a[100:103], v[44:47], a[48:63]
    v_mul_f32 v164, v164, v18
    v_mul_f32 v165, v165, v18
    v_mul_f32 v166, v166, v18
    v_mul_f32 v167, v167, v18
    v_mul_f32 v168, v168, v18
    s_waitcnt lgkmcnt(0)
    v_mfma_f32_32x32x16_bf16 a[0:15], a[64:67], v[48:51], a[0:15]
    ds_read_b64_tr_b16 a[88:89], v10 offset:14336
    ds_read_b64_tr_b16 a[90:91], v10 offset:15360
    ds_read_b64_tr_b16 a[92:93], v11 offset:14336
    ds_read_b64_tr_b16 a[94:95], v11 offset:15360
    v_mfma_f32_32x32x16_bf16 a[16:31], a[68:71], v[48:51], a[16:31]
    ds_read_b64_tr_b16 a[96:97], v12 offset:14336
    ds_read_b64_tr_b16 a[98:99], v12 offset:15360
    ds_read_b64_tr_b16 a[100:101], v13 offset:14336
    ds_read_b64_tr_b16 a[102:103], v13 offset:15360
    v_mfma_f32_32x32x16_bf16 a[32:47], a[72:75], v[48:51], a[32:47]
    v_mul_f32 v169, v169, v18
    v_mul_f32 v170, v170, v18
    v_mul_f32 v171, v171, v18
    v_mul_f32 v172, v172, v18
    v_mul_f32_e64 v173, v173, v18
    v_mfma_f32_32x32x16_bf16 a[48:63], a[76:79], v[48:51], a[48:63]
    v_mul_f32 v174, v174, v18
    v_mul_f32 v175, v175, v18
    v_cvt_pk_bf16_f32 v160, v160, v161
    v_cvt_pk_bf16_f32 v161, v162, v163
    v_cvt_pk_bf16_f32 v162, v164, v165
    s_waitcnt lgkmcnt(0)
    v_mfma_f32_32x32x16_bf16 a[0:15], a[88:91], v[52:55], a[0:15]
    ds_read_b64_tr_b16 a[64:65], v10 offset:24576
    ds_read_b64_tr_b16 a[66:67], v10 offset:25600
    ds_read_b64_tr_b16 a[68:69], v11 offset:24576
    ds_read_b64_tr_b16 a[70:71], v11 offset:25600
    v_mfma_f32_32x32x16_bf16 a[16:31], a[92:95], v[52:55], a[16:31]
    ds_read_b64_tr_b16 a[72:73], v12 offset:24576
    ds_read_b64_tr_b16 a[74:75], v12 offset:25600
    ds_read_b64_tr_b16 a[76:77], v13 offset:24576
    ds_read_b64_tr_b16 a[78:79], v13 offset:25600
    v_mfma_f32_32x32x16_bf16 a[32:47], a[96:99], v[52:55], a[32:47]
    v_cvt_pk_bf16_f32 v163, v166, v167
    s_add_u32 s63, s86, 0
    s_add_u32 s64, s86, 65536
    v_cvt_pk_bf16_f32 v164, v168, v169
    v_cvt_pk_bf16_f32 v165, v170, v171
    v_mfma_f32_32x32x16_bf16 a[48:63], a[100:103], v[52:55], a[48:63]
    v_cvt_pk_bf16_f32 v166, v172, v173
    v_cvt_pk_bf16_f32 v167, v174, v175
    v_mov_b32 v168, 0
    v_mov_b32 v169, 0
    buffer_store_dwordx4 v[160:163], v17, s[40:43], s63 offen sc1
    s_waitcnt lgkmcnt(0)
    v_mfma_f32_32x32x16_bf16 a[0:15], a[64:67], v[56:59], a[0:15]
    ds_read_b64_tr_b16 a[88:89], v10 offset:26624
    ds_read_b64_tr_b16 a[90:91], v10 offset:27648
    ds_read_b64_tr_b16 a[92:93], v11 offset:26624
    ds_read_b64_tr_b16 a[94:95], v11 offset:27648
    v_mfma_f32_32x32x16_bf16 a[16:31], a[68:71], v[56:59], a[16:31]
    ds_read_b64_tr_b16 a[96:97], v12 offset:26624
    ds_read_b64_tr_b16 a[98:99], v12 offset:27648
    ds_read_b64_tr_b16 a[100:101], v13 offset:26624
    ds_read_b64_tr_b16 a[102:103], v13 offset:27648
    v_mfma_f32_32x32x16_bf16 a[32:47], a[72:75], v[56:59], a[32:47]
    buffer_store_dwordx4 v[164:167], v17, s[40:43], s64 offen sc1
    v_dot2c_f32_bf16 v168, v160, v160
    v_dot2c_f32_bf16 v169, v164, v164
    v_dot2c_f32_bf16 v168, v161, v161
    v_dot2c_f32_bf16 v169, v165, v165
    v_mfma_f32_32x32x16_bf16 a[48:63], a[76:79], v[56:59], a[48:63]
    v_dot2c_f32_bf16 v168, v162, v162
    v_dot2c_f32_bf16 v169, v166, v166
    v_dot2c_f32_bf16 v168, v163, v163
    v_dot2c_f32_bf16 v169, v167, v167
    v_mul_f32_e64 v176, v176, v18
    s_waitcnt lgkmcnt(0)
    v_mfma_f32_32x32x16_bf16 a[0:15], a[88:91], v[60:63], a[0:15]
    s_waitcnt vmcnt(12)
    s_barrier
    ds_read_b64_tr_b16 a[64:65], v10 offset:36864
    ds_read_b64_tr_b16 a[66:67], v10 offset:37888
    ds_read_b64_tr_b16 a[68:69], v11 offset:36864
    ds_read_b64_tr_b16 a[70:71], v11 offset:37888
    v_mfma_f32_32x32x16_bf16 a[16:31], a[92:95], v[60:63], a[16:31]
    ds_read_b64_tr_b16 a[72:73], v12 offset:36864
    ds_read_b64_tr_b16 a[74:75], v12 offset:37888
    ds_read_b64_tr_b16 a[76:77], v13 offset:36864
    ds_read_b64_tr_b16 a[78:79], v13 offset:37888
    v_mfma_f32_32x32x16_bf16 a[32:47], a[96:99], v[60:63], a[32:47]
    s_add_u32 s61, s89, 384
    s_and_b32 s61, s61, 511
    s_add_u32 m0, s58, 49152
    s_mul_i32 s47, s61, s73
    buffer_load_dwordx4 v23, s[32:35], s47 offen lds
    v_mul_f32 v177, v177, v18
    v_mul_f32 v178, v178, v18
    v_mul_f32 v179, v179, v18
    v_max3_f32 v28, v168, v169, v28
    v_mul_f32_e64 v180, v180, v18
    v_mfma_f32_32x32x16_bf16 a[48:63], a[100:103], v[60:63], a[48:63]
    s_add_u32 m0, s58, 53248
    s_mul_i32 s48, s61, s74
    buffer_load_dwordx4 v24, s[36:39], s48 offen lds
    v_mul_f32 v181, v181, v18
    v_mul_f32 v182, v182, v18
    v_mul_f32 v183, v183, v18
    v_mul_f32 v184, v184, v18
    v_mul_f32_e64 v185, v185, v18
    s_waitcnt lgkmcnt(0)
    v_mfma_f32_32x32x16_bf16 a[0:15], a[64:67], v[64:67], a[0:15]
    ds_read_b64_tr_b16 a[88:89], v10 offset:38912
    ds_read_b64_tr_b16 a[90:91], v10 offset:39936
    ds_read_b64_tr_b16 a[92:93], v11 offset:38912
    ds_read_b64_tr_b16 a[94:95], v11 offset:39936
    v_mfma_f32_32x32x16_bf16 a[16:31], a[68:71], v[64:67], a[16:31]
    ds_read_b64_tr_b16 a[96:97], v12 offset:38912
    ds_read_b64_tr_b16 a[98:99], v12 offset:39936
    ds_read_b64_tr_b16 a[100:101], v13 offset:38912
    ds_read_b64_tr_b16 a[102:103], v13 offset:39936
    v_mfma_f32_32x32x16_bf16 a[32:47], a[72:75], v[64:67], a[32:47]
    s_add_u32 s61, s89, 416
    s_and_b32 s61, s61, 511
    s_add_u32 m0, s58, 61440
    s_mul_i32 s47, s61, s73
    buffer_load_dwordx4 v23, s[32:35], s47 offen lds
    v_mul_f32 v186, v186, v18
    v_mul_f32 v187, v187, v18
    v_mul_f32 v188, v188, v18
    v_mul_f32 v189, v189, v18
    v_mul_f32 v190, v190, v18
    v_mfma_f32_32x32x16_bf16 a[48:63], a[76:79], v[64:67], a[48:63]
    s_add_u32 m0, s58, 65536
    s_mul_i32 s48, s61, s74
    buffer_load_dwordx4 v24, s[36:39], s48 offen lds
    v_mul_f32 v191, v191, v18
    v_cvt_pk_bf16_f32 v176, v176, v177
    v_cvt_pk_bf16_f32 v177, v178, v179
    v_cvt_pk_bf16_f32 v178, v180, v181
    v_cvt_pk_bf16_f32 v179, v182, v183
    s_waitcnt lgkmcnt(0)
    v_mfma_f32_32x32x16_bf16 a[0:15], a[88:91], v[68:71], a[0:15]
    ds_read_b64_tr_b16 a[64:65], v10 offset:49152
    ds_read_b64_tr_b16 a[66:67], v10 offset:50176
    ds_read_b64_tr_b16 a[68:69], v11 offset:49152
    ds_read_b64_tr_b16 a[70:71], v11 offset:50176
    v_mfma_f32_32x32x16_bf16 a[16:31], a[92:95], v[68:71], a[16:31]
    ds_read_b64_tr_b16 a[72:73], v12 offset:49152
    ds_read_b64_tr_b16 a[74:75], v12 offset:50176
    ds_read_b64_tr_b16 a[76:77], v13 offset:49152
    ds_read_b64_tr_b16 a[78:79], v13 offset:50176
    v_mfma_f32_32x32x16_bf16 a[32:47], a[96:99], v[68:71], a[32:47]
    s_add_u32 s61, s89, 448
    s_and_b32 s61, s61, 511
    s_add_u32 m0, s58, 73728
    s_mul_i32 s47, s61, s73
    buffer_load_dwordx4 v23, s[32:35], s47 offen lds
    s_add_u32 s63, s86, 131072
    s_add_u32 s64, s86, 196608
    v_cvt_pk_bf16_f32 v180, v184, v185
    v_cvt_pk_bf16_f32 v181, v186, v187
    v_cvt_pk_bf16_f32 v182, v188, v189
    v_mfma_f32_32x32x16_bf16 a[48:63], a[100:103], v[68:71], a[48:63]
    s_add_u32 m0, s58, 77824
    s_mul_i32 s48, s61, s74
    buffer_load_dwordx4 v24, s[36:39], s48 offen lds
    v_cvt_pk_bf16_f32 v183, v190, v191
    v_mov_b32 v184, 0
    v_mov_b32_e64 v185, 0
    buffer_store_dwordx4 v[176:179], v17, s[40:43], s63 offen sc1
    buffer_store_dwordx4 v[180:183], v17, s[40:43], s64 offen sc1
    s_waitcnt lgkmcnt(0)
    v_mfma_f32_32x32x16_bf16 a[0:15], a[64:67], v[72:75], a[0:15]
    ds_read_b64_tr_b16 a[88:89], v10 offset:51200
    ds_read_b64_tr_b16 a[90:91], v10 offset:52224
    ds_read_b64_tr_b16 a[92:93], v11 offset:51200
    ds_read_b64_tr_b16 a[94:95], v11 offset:52224
    v_mfma_f32_32x32x16_bf16 a[16:31], a[68:71], v[72:75], a[16:31]
    ds_read_b64_tr_b16 a[96:97], v12 offset:51200
    ds_read_b64_tr_b16 a[98:99], v12 offset:52224
    ds_read_b64_tr_b16 a[100:101], v13 offset:51200
    ds_read_b64_tr_b16 a[102:103], v13 offset:52224
    v_mfma_f32_32x32x16_bf16 a[32:47], a[72:75], v[72:75], a[32:47]
    s_add_u32 s61, s89, 480
    s_and_b32 s61, s61, 511
    s_add_u32 m0, s58, 86016
    s_mul_i32 s47, s61, s73
    buffer_load_dwordx4 v23, s[32:35], s47 offen lds
    v_dot2c_f32_bf16 v184, v176, v176
    v_dot2c_f32_bf16 v185, v180, v180
    v_dot2c_f32_bf16 v184, v177, v177
    v_dot2c_f32_bf16 v185, v181, v181
    v_dot2c_f32_bf16 v184, v178, v178
    v_mfma_f32_32x32x16_bf16 a[48:63], a[76:79], v[72:75], a[48:63]
    s_add_u32 m0, s58, 90112
    s_mul_i32 s48, s61, s74
    buffer_load_dwordx4 v24, s[36:39], s48 offen lds
    v_dot2c_f32_bf16 v185, v182, v182
    v_dot2c_f32_bf16 v184, v179, v179
    v_dot2c_f32_bf16 v185, v183, v183
    s_add_u32 s65, s85, 1
    s_lshr_b32 s62, s65, 3
    s_waitcnt lgkmcnt(0)
    v_mfma_f32_32x32x16_bf16 a[0:15], a[88:91], v[76:79], a[0:15]
    v_add_u32 v10, 61440, v10
    v_add_u32 v11, 61440, v11
    v_add_u32 v12, 61440, v12
    v_add_u32 v13, 61440, v13
    v_add_u32 v14, 61440, v14
    v_add_u32 v15, 61440, v15
    ds_read_b64_tr_b16 a[64:65], v10 offset:0
    ds_read_b64_tr_b16 a[66:67], v10 offset:1024
    ds_read_b64_tr_b16 a[68:69], v11 offset:0
    ds_read_b64_tr_b16 a[70:71], v11 offset:1024
    v_mfma_f32_32x32x16_bf16 a[16:31], a[92:95], v[76:79], a[16:31]
    ds_read_b64_tr_b16 a[72:73], v12 offset:0
    ds_read_b64_tr_b16 a[74:75], v12 offset:1024
    ds_read_b64_tr_b16 a[76:77], v13 offset:0
    ds_read_b64_tr_b16 a[78:79], v13 offset:1024
    v_mfma_f32_32x32x16_bf16 a[32:47], a[96:99], v[76:79], a[32:47]
    s_and_b32 s63, s65, 7
    s_lshl_b32 s63, s63, 18
    v_max3_f32 v28, v184, v185, v28
    s_lshl_b32 s64, s62, 21
    s_add_u32 s63, s63, s64
    v_mfma_f32_32x32x16_bf16 a[48:63], a[100:103], v[76:79], a[48:63]
    s_add_u32 s86, s63, s83
    s_cmp_eq_u32 s62, 0
    s_cselect_b32 s82, 0x3eb8aa3b, 1.0
    s_cmp_eq_u32 s62, 2
    s_cselect_b64 s[80:81], -1, 0
    v_mul_f32_e64 v18, s82, v25
    v_cndmask_b32 v17, v30, v31, s[80:81]
    s_waitcnt lgkmcnt(0)
    v_mfma_f32_32x32x16_bf16 a[0:15], a[64:67], v[80:83], a[0:15]
    ds_read_b64_tr_b16 a[88:89], v10 offset:2048
    ds_read_b64_tr_b16 a[90:91], v10 offset:3072
    ds_read_b64_tr_b16 a[92:93], v11 offset:2048
    ds_read_b64_tr_b16 a[94:95], v11 offset:3072
    v_mfma_f32_32x32x16_bf16 a[16:31], a[68:71], v[80:83], a[16:31]
    ds_read_b64_tr_b16 a[96:97], v12 offset:2048
    ds_read_b64_tr_b16 a[98:99], v12 offset:3072
    ds_read_b64_tr_b16 a[100:101], v13 offset:2048
    ds_read_b64_tr_b16 a[102:103], v13 offset:3072
    v_mfma_f32_32x32x16_bf16 a[32:47], a[72:75], v[80:83], a[32:47]
    v_mul_f32 v192, v192, v18
    v_mul_f32 v193, v193, v18
    v_mul_f32 v194, v194, v18
    v_mul_f32 v195, v195, v18
    v_mul_f32 v196, v196, v18
    v_mfma_f32_32x32x16_bf16 a[48:63], a[76:79], v[80:83], a[48:63]
    v_mul_f32 v197, v197, v18
    v_mul_f32 v198, v198, v18
    v_mul_f32 v199, v199, v18
    v_mul_f32 v200, v200, v18
    v_mul_f32 v201, v201, v18
    s_waitcnt lgkmcnt(0)
    v_mfma_f32_32x32x16_bf16 a[0:15], a[88:91], v[84:87], a[0:15]
    ds_read_b64_tr_b16 a[64:65], v10 offset:12288
    ds_read_b64_tr_b16 a[66:67], v10 offset:13312
    ds_read_b64_tr_b16 a[68:69], v11 offset:12288
    ds_read_b64_tr_b16 a[70:71], v11 offset:13312
    v_mfma_f32_32x32x16_bf16 a[16:31], a[92:95], v[84:87], a[16:31]
    ds_read_b64_tr_b16 a[72:73], v12 offset:12288
    ds_read_b64_tr_b16 a[74:75], v12 offset:13312
    ds_read_b64_tr_b16 a[76:77], v13 offset:12288
    ds_read_b64_tr_b16 a[78:79], v13 offset:13312
    v_mfma_f32_32x32x16_bf16 a[32:47], a[96:99], v[84:87], a[32:47]
    v_mul_f32 v202, v202, v18
    v_mul_f32 v203, v203, v18
    v_mul_f32 v204, v204, v18
    v_mul_f32 v205, v205, v18
    v_mul_f32_e64 v206, v206, v18
    v_mfma_f32_32x32x16_bf16 a[48:63], a[100:103], v[84:87], a[48:63]
    v_mul_f32_e64 v207, v207, v18
    v_cvt_pk_bf16_f32 v192, v192, v193
    v_cvt_pk_bf16_f32 v193, v194, v195
    v_cvt_pk_bf16_f32 v194, v196, v197
    v_cvt_pk_bf16_f32 v195, v198, v199
    s_waitcnt lgkmcnt(0)
    v_mfma_f32_32x32x16_bf16 a[0:15], a[64:67], v[88:91], a[0:15]
    ds_read_b64_tr_b16 a[88:89], v10 offset:14336
    ds_read_b64_tr_b16 a[90:91], v10 offset:15360
    ds_read_b64_tr_b16 a[92:93], v11 offset:14336
    ds_read_b64_tr_b16 a[94:95], v11 offset:15360
    v_mfma_f32_32x32x16_bf16 a[16:31], a[68:71], v[88:91], a[16:31]
    ds_read_b64_tr_b16 a[96:97], v12 offset:14336
    ds_read_b64_tr_b16 a[98:99], v12 offset:15360
    ds_read_b64_tr_b16 a[100:101], v13 offset:14336
    ds_read_b64_tr_b16 a[102:103], v13 offset:15360
    v_mfma_f32_32x32x16_bf16 a[32:47], a[72:75], v[88:91], a[32:47]
    s_add_u32 s63, s86, 0
    s_add_u32 s64, s86, 65536
    v_cvt_pk_bf16_f32 v196, v200, v201
    v_cvt_pk_bf16_f32 v197, v202, v203
    v_cvt_pk_bf16_f32 v198, v204, v205
    v_mfma_f32_32x32x16_bf16 a[48:63], a[76:79], v[88:91], a[48:63]
    v_cvt_pk_bf16_f32 v199, v206, v207
    v_mov_b32 v200, 0
    v_mov_b32 v201, 0
    buffer_store_dwordx4 v[192:195], v17, s[40:43], s63 offen sc1
    buffer_store_dwordx4 v[196:199], v17, s[40:43], s64 offen sc1
    s_waitcnt lgkmcnt(0)
    v_mfma_f32_32x32x16_bf16 a[0:15], a[88:91], v[92:95], a[0:15]
    s_waitcnt vmcnt(14)
    s_barrier
    v_add_u32 v10, 4294844416, v10
    v_add_u32 v11, 4294844416, v11
    v_add_u32 v12, 4294844416, v12
    v_add_u32 v13, 4294844416, v13
    v_add_u32 v14, 4294844416, v14
    v_add_u32 v15, 4294844416, v15
    ds_read_b64_tr_b16 a[64:65], v10 offset:0
    ds_read_b64_tr_b16 a[66:67], v10 offset:1024
    ds_read_b64_tr_b16 a[68:69], v11 offset:0
    ds_read_b64_tr_b16 a[70:71], v11 offset:1024
    v_mfma_f32_32x32x16_bf16 a[16:31], a[92:95], v[92:95], a[16:31]
    ds_read_b64_tr_b16 a[72:73], v12 offset:0
    ds_read_b64_tr_b16 a[74:75], v12 offset:1024
    ds_read_b64_tr_b16 a[76:77], v13 offset:0
    ds_read_b64_tr_b16 a[78:79], v13 offset:1024
    v_mfma_f32_32x32x16_bf16 a[32:47], a[96:99], v[92:95], a[32:47]
    v_dot2c_f32_bf16 v200, v192, v192
    v_dot2c_f32_bf16 v201, v196, v196
    v_dot2c_f32_bf16 v200, v193, v193
    v_dot2c_f32_bf16 v201, v197, v197
    v_dot2c_f32_bf16 v200, v194, v194
    v_mfma_f32_32x32x16_bf16 a[48:63], a[100:103], v[92:95], a[48:63]
    v_dot2c_f32_bf16 v201, v198, v198
    v_dot2c_f32_bf16 v200, v195, v195
    v_dot2c_f32_bf16 v201, v199, v199
    v_mul_f32 v208, v208, v18
    v_mul_f32 v209, v209, v18
    s_waitcnt lgkmcnt(0)
    v_mfma_f32_32x32x16_bf16 a[0:15], a[64:67], v[96:99], a[0:15]
    ds_read_b64_tr_b16 a[88:89], v10 offset:2048
    ds_read_b64_tr_b16 a[90:91], v10 offset:3072
    ds_read_b64_tr_b16 a[92:93], v11 offset:2048
    ds_read_b64_tr_b16 a[94:95], v11 offset:3072
    v_mfma_f32_32x32x16_bf16 a[16:31], a[68:71], v[96:99], a[16:31]
    ds_read_b64_tr_b16 a[96:97], v12 offset:2048
    ds_read_b64_tr_b16 a[98:99], v12 offset:3072
    ds_read_b64_tr_b16 a[100:101], v13 offset:2048
    ds_read_b64_tr_b16 a[102:103], v13 offset:3072
    v_mfma_f32_32x32x16_bf16 a[32:47], a[72:75], v[96:99], a[32:47]
    v_mul_f32 v210, v210, v18
    v_mul_f32 v211, v211, v18
    v_max3_f32 v28, v200, v201, v28
    v_mul_f32 v212, v212, v18
    v_mul_f32 v213, v213, v18
    v_mfma_f32_32x32x16_bf16 a[48:63], a[76:79], v[96:99], a[48:63]
    v_mul_f32 v214, v214, v18
    v_mul_f32 v215, v215, v18
    v_mul_f32 v216, v216, v18
    v_mul_f32 v217, v217, v18
    v_mul_f32 v218, v218, v18
    s_waitcnt lgkmcnt(0)
    v_mfma_f32_32x32x16_bf16 a[0:15], a[88:91], v[100:103], a[0:15]
    ds_read_b64_tr_b16 a[64:65], v10 offset:12288
    ds_read_b64_tr_b16 a[66:67], v10 offset:13312
    ds_read_b64_tr_b16 a[68:69], v11 offset:12288
    ds_read_b64_tr_b16 a[70:71], v11 offset:13312
    v_mfma_f32_32x32x16_bf16 a[16:31], a[92:95], v[100:103], a[16:31]
    ds_read_b64_tr_b16 a[72:73], v12 offset:12288
    ds_read_b64_tr_b16 a[74:75], v12 offset:13312
    ds_read_b64_tr_b16 a[76:77], v13 offset:12288
    ds_read_b64_tr_b16 a[78:79], v13 offset:13312
    v_mfma_f32_32x32x16_bf16 a[32:47], a[96:99], v[100:103], a[32:47]
    v_mul_f32 v219, v219, v18
    v_mul_f32 v220, v220, v18
    v_mul_f32 v221, v221, v18
    v_mul_f32 v222, v222, v18
    v_mul_f32_e64 v223, v223, v18
    v_mfma_f32_32x32x16_bf16 a[48:63], a[100:103], v[100:103], a[48:63]
    v_cvt_pk_bf16_f32 v208, v208, v209
    v_cvt_pk_bf16_f32 v209, v210, v211
    v_cvt_pk_bf16_f32 v210, v212, v213
    v_cvt_pk_bf16_f32 v211, v214, v215
    s_add_u32 s63, s86, 131072
    s_waitcnt lgkmcnt(0)
    v_mfma_f32_32x32x16_bf16 a[0:15], a[64:67], v[104:107], a[0:15]
    ds_read_b64_tr_b16 a[88:89], v10 offset:14336
    ds_read_b64_tr_b16 a[90:91], v10 offset:15360
    ds_read_b64_tr_b16 a[92:93], v11 offset:14336
    ds_read_b64_tr_b16 a[94:95], v11 offset:15360
    v_mfma_f32_32x32x16_bf16 a[16:31], a[68:71], v[104:107], a[16:31]
    ds_read_b64_tr_b16 a[96:97], v12 offset:14336
    ds_read_b64_tr_b16 a[98:99], v12 offset:15360
    ds_read_b64_tr_b16 a[100:101], v13 offset:14336
    ds_read_b64_tr_b16 a[102:103], v13 offset:15360
    v_mfma_f32_32x32x16_bf16 a[32:47], a[72:75], v[104:107], a[32:47]
    s_add_u32 s64, s86, 196608
    v_cvt_pk_bf16_f32 v212, v216, v217
    v_cvt_pk_bf16_f32 v213, v218, v219
    v_cvt_pk_bf16_f32 v214, v220, v221
    v_cvt_pk_bf16_f32 v215, v222, v223
    v_mfma_f32_32x32x16_bf16 a[48:63], a[76:79], v[104:107], a[48:63]
    v_mov_b32 v216, 0
    v_mov_b32_e64 v217, 0
    buffer_store_dwordx4 v[208:211], v17, s[40:43], s63 offen sc1
    buffer_store_dwordx4 v[212:215], v17, s[40:43], s64 offen sc1
    v_dot2c_f32_bf16 v216, v208, v208
    s_waitcnt lgkmcnt(0)
    v_mfma_f32_32x32x16_bf16 a[0:15], a[88:91], v[108:111], a[0:15]
    ds_read_b64_tr_b16 a[64:65], v10 offset:24576
    ds_read_b64_tr_b16 a[66:67], v10 offset:25600
    ds_read_b64_tr_b16 a[68:69], v11 offset:24576
    ds_read_b64_tr_b16 a[70:71], v11 offset:25600
    v_mfma_f32_32x32x16_bf16 a[16:31], a[92:95], v[108:111], a[16:31]
    ds_read_b64_tr_b16 a[72:73], v12 offset:24576
    ds_read_b64_tr_b16 a[74:75], v12 offset:25600
    ds_read_b64_tr_b16 a[76:77], v13 offset:24576
    ds_read_b64_tr_b16 a[78:79], v13 offset:25600
    v_mfma_f32_32x32x16_bf16 a[32:47], a[96:99], v[108:111], a[32:47]
    v_dot2c_f32_bf16 v217, v212, v212
    v_dot2c_f32_bf16 v216, v209, v209
    v_dot2c_f32_bf16 v217, v213, v213
    v_dot2c_f32_bf16 v216, v210, v210
    v_dot2c_f32_bf16 v217, v214, v214
    v_mfma_f32_32x32x16_bf16 a[48:63], a[100:103], v[108:111], a[48:63]
    v_dot2c_f32_bf16 v216, v211, v211
    v_dot2c_f32_bf16 v217, v215, v215
    s_add_u32 s65, s85, 2
    s_lshr_b32 s62, s65, 3
    s_and_b32 s63, s65, 7
    s_waitcnt lgkmcnt(0)
    v_mfma_f32_32x32x16_bf16 a[0:15], a[64:67], v[112:115], a[0:15]
    ds_read_b64_tr_b16 a[88:89], v10 offset:26624
    ds_read_b64_tr_b16 a[90:91], v10 offset:27648
    ds_read_b64_tr_b16 a[92:93], v11 offset:26624
    ds_read_b64_tr_b16 a[94:95], v11 offset:27648
    v_mfma_f32_32x32x16_bf16 a[16:31], a[68:71], v[112:115], a[16:31]
    ds_read_b64_tr_b16 a[96:97], v12 offset:26624
    ds_read_b64_tr_b16 a[98:99], v12 offset:27648
    ds_read_b64_tr_b16 a[100:101], v13 offset:26624
    ds_read_b64_tr_b16 a[102:103], v13 offset:27648
    v_mfma_f32_32x32x16_bf16 a[32:47], a[72:75], v[112:115], a[32:47]
    s_lshl_b32 s63, s63, 18
    v_max3_f32 v28, v216, v217, v28
    s_lshl_b32 s64, s62, 21
    s_add_u32 s63, s63, s64
    s_add_u32 s86, s63, s83
    v_mfma_f32_32x32x16_bf16 a[48:63], a[76:79], v[112:115], a[48:63]
    s_cmp_eq_u32 s62, 0
    s_cselect_b32 s82, 0x3eb8aa3b, 1.0
    s_cmp_eq_u32 s62, 2
    s_cselect_b64 s[80:81], -1, 0
    v_mul_f32_e64 v18, s82, v25
    v_cndmask_b32 v17, v30, v31, s[80:81]
    v_mul_f32 v224, v224, v18
    s_waitcnt lgkmcnt(0)
    v_mfma_f32_32x32x16_bf16 a[0:15], a[88:91], v[116:119], a[0:15]
    ds_read_b64_tr_b16 a[64:65], v10 offset:36864
    ds_read_b64_tr_b16 a[66:67], v10 offset:37888
    ds_read_b64_tr_b16 a[68:69], v11 offset:36864
    ds_read_b64_tr_b16 a[70:71], v11 offset:37888
    v_mfma_f32_32x32x16_bf16 a[16:31], a[92:95], v[116:119], a[16:31]
    ds_read_b64_tr_b16 a[72:73], v12 offset:36864
    ds_read_b64_tr_b16 a[74:75], v12 offset:37888
    ds_read_b64_tr_b16 a[76:77], v13 offset:36864
    ds_read_b64_tr_b16 a[78:79], v13 offset:37888
    v_mfma_f32_32x32x16_bf16 a[32:47], a[96:99], v[116:119], a[32:47]
    v_mul_f32 v225, v225, v18
    v_mul_f32 v226, v226, v18
    v_mul_f32 v227, v227, v18
    v_mul_f32 v228, v228, v18
    v_mul_f32_e64 v229, v229, v18
    v_mfma_f32_32x32x16_bf16 a[48:63], a[100:103], v[116:119], a[48:63]
    v_mul_f32 v230, v230, v18
    v_mul_f32 v231, v231, v18
    v_mul_f32 v232, v232, v18
    v_mul_f32 v233, v233, v18
    v_mul_f32 v234, v234, v18
    s_waitcnt lgkmcnt(0)
    v_mfma_f32_32x32x16_bf16 a[0:15], a[64:67], v[120:123], a[0:15]
    ds_read_b64_tr_b16 a[88:89], v10 offset:38912
    ds_read_b64_tr_b16 a[90:91], v10 offset:39936
    ds_read_b64_tr_b16 a[92:93], v11 offset:38912
    ds_read_b64_tr_b16 a[94:95], v11 offset:39936
    v_mfma_f32_32x32x16_bf16 a[16:31], a[68:71], v[120:123], a[16:31]
    ds_read_b64_tr_b16 a[96:97], v12 offset:38912
    ds_read_b64_tr_b16 a[98:99], v12 offset:39936
    ds_read_b64_tr_b16 a[100:101], v13 offset:38912
    ds_read_b64_tr_b16 a[102:103], v13 offset:39936
    v_mfma_f32_32x32x16_bf16 a[32:47], a[72:75], v[120:123], a[32:47]
    v_mul_f32 v235, v235, v18
    v_mul_f32 v236, v236, v18
    v_mul_f32 v237, v237, v18
    v_mul_f32 v238, v238, v18
    v_mul_f32_e64 v239, v239, v18
    v_mfma_f32_32x32x16_bf16 a[48:63], a[76:79], v[120:123], a[48:63]
    v_cvt_pk_bf16_f32 v224, v224, v225
    v_cvt_pk_bf16_f32 v225, v226, v227
    v_cvt_pk_bf16_f32 v226, v228, v229
    v_cvt_pk_bf16_f32 v227, v230, v231
    s_add_u32 s63, s86, 0
    s_waitcnt lgkmcnt(0)
    v_mfma_f32_32x32x16_bf16 a[0:15], a[88:91], v[124:127], a[0:15]
    s_waitcnt vmcnt(4)
    s_barrier
    ds_read_b64_tr_b16 a[64:65], v10 offset:49152
    ds_read_b64_tr_b16 a[66:67], v10 offset:50176
    ds_read_b64_tr_b16 a[68:69], v11 offset:49152
    ds_read_b64_tr_b16 a[70:71], v11 offset:50176
    v_mfma_f32_32x32x16_bf16 a[16:31], a[92:95], v[124:127], a[16:31]
    ds_read_b64_tr_b16 a[72:73], v12 offset:49152
    ds_read_b64_tr_b16 a[74:75], v12 offset:50176
    ds_read_b64_tr_b16 a[76:77], v13 offset:49152
    ds_read_b64_tr_b16 a[78:79], v13 offset:50176
    v_mfma_f32_32x32x16_bf16 a[32:47], a[96:99], v[124:127], a[32:47]
    s_add_u32 s64, s86, 65536
    v_cvt_pk_bf16_f32 v228, v232, v233
    v_cvt_pk_bf16_f32 v229, v234, v235
    v_cvt_pk_bf16_f32 v230, v236, v237
    v_cvt_pk_bf16_f32 v231, v238, v239
    v_mfma_f32_32x32x16_bf16 a[48:63], a[100:103], v[124:127], a[48:63]
    v_mov_b32 v232, 0
    v_mov_b32 v233, 0
    buffer_store_dwordx4 v[224:227], v17, s[40:43], s63 offen sc1
    buffer_store_dwordx4 v[228:231], v17, s[40:43], s64 offen sc1
    v_dot2c_f32_bf16 v232, v224, v224
    s_waitcnt lgkmcnt(0)
    v_mfma_f32_32x32x16_bf16 a[0:15], a[64:67], v[128:131], a[0:15]
    ds_read_b64_tr_b16 a[88:89], v10 offset:51200
    ds_read_b64_tr_b16 a[90:91], v10 offset:52224
    ds_read_b64_tr_b16 a[92:93], v11 offset:51200
    ds_read_b64_tr_b16 a[94:95], v11 offset:52224
    v_mfma_f32_32x32x16_bf16 a[16:31], a[68:71], v[128:131], a[16:31]
    ds_read_b64_tr_b16 a[96:97], v12 offset:51200
    ds_read_b64_tr_b16 a[98:99], v12 offset:52224
    ds_read_b64_tr_b16 a[100:101], v13 offset:51200
    ds_read_b64_tr_b16 a[102:103], v13 offset:52224
    v_mfma_f32_32x32x16_bf16 a[32:47], a[72:75], v[128:131], a[32:47]
    v_dot2c_f32_bf16 v233, v228, v228
    v_dot2c_f32_bf16 v232, v225, v225
    v_dot2c_f32_bf16 v233, v229, v229
    v_dot2c_f32_bf16 v232, v226, v226
    v_dot2c_f32_bf16 v233, v230, v230
    v_mfma_f32_32x32x16_bf16 a[48:63], a[76:79], v[128:131], a[48:63]
    v_dot2c_f32_bf16 v232, v227, v227
    v_dot2c_f32_bf16 v233, v231, v231
    v_mul_f32 v240, v240, v18
    v_mul_f32 v241, v241, v18
    v_mul_f32_e64 v242, v242, v18
    s_waitcnt lgkmcnt(0)
    v_mfma_f32_32x32x16_bf16 a[0:15], a[88:91], v[132:135], a[0:15]
    v_add_u32 v10, 61440, v10
    v_add_u32 v11, 61440, v11
    v_add_u32 v12, 61440, v12
    v_add_u32 v13, 61440, v13
    v_add_u32 v14, 61440, v14
    v_add_u32 v15, 61440, v15
    ds_read_b64_tr_b16 a[64:65], v10 offset:0
    ds_read_b64_tr_b16 a[66:67], v10 offset:1024
    ds_read_b64_tr_b16 a[68:69], v11 offset:0
    ds_read_b64_tr_b16 a[70:71], v11 offset:1024
    v_mfma_f32_32x32x16_bf16 a[16:31], a[92:95], v[132:135], a[16:31]
    ds_read_b64_tr_b16 a[72:73], v12 offset:0
    ds_read_b64_tr_b16 a[74:75], v12 offset:1024
    ds_read_b64_tr_b16 a[76:77], v13 offset:0
    ds_read_b64_tr_b16 a[78:79], v13 offset:1024
    v_mfma_f32_32x32x16_bf16 a[32:47], a[96:99], v[132:135], a[32:47]
    v_mul_f32_e64 v243, v243, v18
    v_max3_f32 v28, v232, v233, v28
    v_mul_f32 v244, v244, v18
    v_mul_f32 v245, v245, v18
    v_mul_f32_e64 v246, v246, v18
    v_mfma_f32_32x32x16_bf16 a[48:63], a[100:103], v[132:135], a[48:63]
    v_mul_f32 v247, v247, v18
    v_mul_f32 v248, v248, v18
    v_mul_f32 v249, v249, v18
    v_mul_f32 v250, v250, v18
    v_mul_f32 v251, v251, v18
    s_waitcnt lgkmcnt(0)
    v_mfma_f32_32x32x16_bf16 a[0:15], a[64:67], v[136:139], a[0:15]
    ds_read_b64_tr_b16 a[88:89], v10 offset:2048
    ds_read_b64_tr_b16 a[90:91], v10 offset:3072
    ds_read_b64_tr_b16 a[92:93], v11 offset:2048
    ds_read_b64_tr_b16 a[94:95], v11 offset:3072
    v_mfma_f32_32x32x16_bf16 a[16:31], a[68:71], v[136:139], a[16:31]
    ds_read_b64_tr_b16 a[96:97], v12 offset:2048
    ds_read_b64_tr_b16 a[98:99], v12 offset:3072
    ds_read_b64_tr_b16 a[100:101], v13 offset:2048
    ds_read_b64_tr_b16 a[102:103], v13 offset:3072
    v_mfma_f32_32x32x16_bf16 a[32:47], a[72:75], v[136:139], a[32:47]
    v_mul_f32 v252, v252, v18
    v_mul_f32 v253, v253, v18
    v_mul_f32 v254, v254, v18
    v_mul_f32 v255, v255, v18
    v_cvt_pk_bf16_f32 v240, v240, v241
    v_mfma_f32_32x32x16_bf16 a[48:63], a[76:79], v[136:139], a[48:63]
    v_cvt_pk_bf16_f32 v241, v242, v243
    v_cvt_pk_bf16_f32 v242, v244, v245
    v_cvt_pk_bf16_f32 v243, v246, v247
    s_add_u32 s63, s86, 131072
    s_add_u32 s64, s86, 196608
    s_waitcnt lgkmcnt(0)
    v_mfma_f32_32x32x16_bf16 a[0:15], a[88:91], v[140:143], a[0:15]
    ds_read_b64_tr_b16 a[64:65], v10 offset:12288
    ds_read_b64_tr_b16 a[66:67], v10 offset:13312
    ds_read_b64_tr_b16 a[68:69], v11 offset:12288
    ds_read_b64_tr_b16 a[70:71], v11 offset:13312
    v_mfma_f32_32x32x16_bf16 a[16:31], a[92:95], v[140:143], a[16:31]
    ds_read_b64_tr_b16 a[72:73], v12 offset:12288
    ds_read_b64_tr_b16 a[74:75], v12 offset:13312
    ds_read_b64_tr_b16 a[76:77], v13 offset:12288
    ds_read_b64_tr_b16 a[78:79], v13 offset:13312
    v_mfma_f32_32x32x16_bf16 a[32:47], a[96:99], v[140:143], a[32:47]
    v_cvt_pk_bf16_f32 v244, v248, v249
    v_cvt_pk_bf16_f32 v245, v250, v251
    v_cvt_pk_bf16_f32 v246, v252, v253
    v_cvt_pk_bf16_f32 v247, v254, v255
    v_mov_b32 v248, 0
    v_mfma_f32_32x32x16_bf16 a[48:63], a[100:103], v[140:143], a[48:63]
    v_mov_b32_e64 v249, 0
    buffer_store_dwordx4 v[240:243], v17, s[40:43], s63 offen sc1
    buffer_store_dwordx4 v[244:247], v17, s[40:43], s64 offen sc1
    v_dot2c_f32_bf16 v248, v240, v240
    v_dot2c_f32_bf16 v249, v244, v244
    s_waitcnt lgkmcnt(0)
    v_mfma_f32_32x32x16_bf16 a[0:15], a[64:67], v[144:147], a[0:15]
    ds_read_b64_tr_b16 a[88:89], v10 offset:14336
    ds_read_b64_tr_b16 a[90:91], v10 offset:15360
    ds_read_b64_tr_b16 a[92:93], v11 offset:14336
    ds_read_b64_tr_b16 a[94:95], v11 offset:15360
    v_mfma_f32_32x32x16_bf16 a[16:31], a[68:71], v[144:147], a[16:31]
    ds_read_b64_tr_b16 a[96:97], v12 offset:14336
    ds_read_b64_tr_b16 a[98:99], v12 offset:15360
    ds_read_b64_tr_b16 a[100:101], v13 offset:14336
    ds_read_b64_tr_b16 a[102:103], v13 offset:15360
    v_mfma_f32_32x32x16_bf16 a[32:47], a[72:75], v[144:147], a[32:47]
    v_dot2c_f32_bf16 v248, v241, v241
    v_dot2c_f32_bf16 v249, v245, v245
    v_dot2c_f32_bf16 v248, v242, v242
    v_dot2c_f32_bf16 v249, v246, v246
    v_mfma_f32_32x32x16_bf16 a[48:63], a[76:79], v[144:147], a[48:63]
    v_dot2c_f32_bf16 v248, v243, v243
    v_dot2c_f32_bf16 v249, v247, v247
    s_nop 2
    v_max3_f32 v28, v248, v249, v28
    s_waitcnt lgkmcnt(0)
    v_mfma_f32_32x32x16_bf16 a[0:15], a[88:91], v[148:151], a[0:15]
    ds_read_b64_tr_b16 a[64:65], v10 offset:24576
    ds_read_b64_tr_b16 a[66:67], v10 offset:25600
    ds_read_b64_tr_b16 a[68:69], v11 offset:24576
    ds_read_b64_tr_b16 a[70:71], v11 offset:25600
    v_mfma_f32_32x32x16_bf16 a[16:31], a[92:95], v[148:151], a[16:31]
    ds_read_b64_tr_b16 a[72:73], v12 offset:24576
    ds_read_b64_tr_b16 a[74:75], v12 offset:25600
    ds_read_b64_tr_b16 a[76:77], v13 offset:24576
    ds_read_b64_tr_b16 a[78:79], v13 offset:25600
    v_mfma_f32_32x32x16_bf16 a[32:47], a[96:99], v[148:151], a[32:47]
    v_mfma_f32_32x32x16_bf16 a[48:63], a[100:103], v[148:151], a[48:63]
    s_waitcnt lgkmcnt(0)
    v_mfma_f32_32x32x16_bf16 a[0:15], a[64:67], v[152:155], a[0:15]
    ds_read_b64_tr_b16 a[88:89], v10 offset:26624
    ds_read_b64_tr_b16 a[90:91], v10 offset:27648
    ds_read_b64_tr_b16 a[92:93], v11 offset:26624
    ds_read_b64_tr_b16 a[94:95], v11 offset:27648
    v_mfma_f32_32x32x16_bf16 a[16:31], a[68:71], v[152:155], a[16:31]
    ds_read_b64_tr_b16 a[96:97], v12 offset:26624
    ds_read_b64_tr_b16 a[98:99], v12 offset:27648
    ds_read_b64_tr_b16 a[100:101], v13 offset:26624
    ds_read_b64_tr_b16 a[102:103], v13 offset:27648
    v_mfma_f32_32x32x16_bf16 a[32:47], a[72:75], v[152:155], a[32:47]
    v_mfma_f32_32x32x16_bf16 a[48:63], a[76:79], v[152:155], a[48:63]
    s_waitcnt lgkmcnt(0)
    v_mfma_f32_32x32x16_bf16 a[0:15], a[88:91], v[156:159], a[0:15]
    v_mfma_f32_32x32x16_bf16 a[16:31], a[92:95], v[156:159], a[16:31]
    v_mfma_f32_32x32x16_bf16 a[32:47], a[96:99], v[156:159], a[32:47]
    v_mfma_f32_32x32x16_bf16 a[48:63], a[100:103], v[156:159], a[48:63]
    s_nop 8
    v_accvgpr_read_b32 v32, a0
    v_accvgpr_read_b32 v33, a1
    v_accvgpr_read_b32 v34, a2
    v_accvgpr_read_b32 v35, a3
    v_accvgpr_read_b32 v36, a4
    v_accvgpr_read_b32 v37, a5
    v_accvgpr_read_b32 v38, a6
    v_accvgpr_read_b32 v39, a7
    v_accvgpr_read_b32 v40, a8
    v_accvgpr_read_b32 v41, a9
    v_accvgpr_read_b32 v42, a10
    v_accvgpr_read_b32 v43, a11
    v_accvgpr_read_b32 v44, a12
    v_accvgpr_read_b32 v45, a13
    v_accvgpr_read_b32 v46, a14
    v_accvgpr_read_b32 v47, a15
    v_accvgpr_read_b32 v48, a16
    v_accvgpr_read_b32 v49, a17
    v_accvgpr_read_b32 v50, a18
    v_accvgpr_read_b32 v51, a19
    v_accvgpr_read_b32 v52, a20
    v_accvgpr_read_b32 v53, a21
    v_accvgpr_read_b32 v54, a22
    v_accvgpr_read_b32 v55, a23
    v_accvgpr_read_b32 v56, a24
    v_accvgpr_read_b32 v57, a25
    v_accvgpr_read_b32 v58, a26
    v_accvgpr_read_b32 v59, a27
    v_accvgpr_read_b32 v60, a28
    v_accvgpr_read_b32 v61, a29
    v_accvgpr_read_b32 v62, a30
    v_accvgpr_read_b32 v63, a31
    v_accvgpr_read_b32 v64, a32
    v_accvgpr_read_b32 v65, a33
    v_accvgpr_read_b32 v66, a34
    v_accvgpr_read_b32 v67, a35
    v_accvgpr_read_b32 v68, a36
    v_accvgpr_read_b32 v69, a37
    v_accvgpr_read_b32 v70, a38
    v_accvgpr_read_b32 v71, a39
    v_accvgpr_read_b32 v72, a40
    v_accvgpr_read_b32 v73, a41
    v_accvgpr_read_b32 v74, a42
    v_accvgpr_read_b32 v75, a43
    v_accvgpr_read_b32 v76, a44
    v_accvgpr_read_b32 v77, a45
    v_accvgpr_read_b32 v78, a46
    v_accvgpr_read_b32 v79, a47
    v_accvgpr_read_b32 v80, a48
    v_accvgpr_read_b32 v81, a49
    v_accvgpr_read_b32 v82, a50
    v_accvgpr_read_b32 v83, a51
    v_accvgpr_read_b32 v84, a52
    v_accvgpr_read_b32 v85, a53
    v_accvgpr_read_b32 v86, a54
    v_accvgpr_read_b32 v87, a55
    v_accvgpr_read_b32 v88, a56
    v_accvgpr_read_b32 v89, a57
    v_accvgpr_read_b32 v90, a58
    v_accvgpr_read_b32 v91, a59
    v_accvgpr_read_b32 v92, a60
    v_accvgpr_read_b32 v93, a61
    v_accvgpr_read_b32 v94, a62
    v_accvgpr_read_b32 v95, a63
    s_add_u32 s65, s85, 3
    s_lshr_b32 s62, s65, 3
    s_and_b32 s63, s65, 7
    s_lshl_b32 s63, s63, 18
    s_lshl_b32 s64, s62, 21
    s_add_u32 s63, s63, s64
    s_add_u32 s86, s63, s83
    s_cmp_eq_u32 s62, 0
    s_cselect_b32 s82, 0x3eb8aa3b, 1.0
    s_cmp_eq_u32 s62, 2
    s_cselect_b64 s[80:81], -1, 0
    v_mul_f32 v18, s82, v25
    v_cndmask_b32 v17, v30, v31, s[80:81]
    v_pk_mul_f32 v[32:33], v[32:33], v[18:19] op_sel_hi:[1,0]
    v_pk_mul_f32 v[34:35], v[34:35], v[18:19] op_sel_hi:[1,0]
    v_pk_mul_f32 v[36:37], v[36:37], v[18:19] op_sel_hi:[1,0]
    v_pk_mul_f32 v[38:39], v[38:39], v[18:19] op_sel_hi:[1,0]
    v_pk_mul_f32 v[40:41], v[40:41], v[18:19] op_sel_hi:[1,0]
    v_pk_mul_f32 v[42:43], v[42:43], v[18:19] op_sel_hi:[1,0]
    v_pk_mul_f32 v[44:45], v[44:45], v[18:19] op_sel_hi:[1,0]
    v_pk_mul_f32 v[46:47], v[46:47], v[18:19] op_sel_hi:[1,0]
    v_cvt_pk_bf16_f32 v32, v32, v33
    v_cvt_pk_bf16_f32 v33, v34, v35
    v_cvt_pk_bf16_f32 v34, v36, v37
    v_cvt_pk_bf16_f32 v35, v38, v39
    s_add_u32 s63, s86, 0
    s_add_u32 s64, s86, 65536
    v_cvt_pk_bf16_f32 v36, v40, v41
    v_cvt_pk_bf16_f32 v37, v42, v43
    v_cvt_pk_bf16_f32 v38, v44, v45
    v_cvt_pk_bf16_f32 v39, v46, v47
    v_mov_b32 v40, 0
    v_mov_b32 v41, 0
    buffer_store_dwordx4 v[32:35], v17, s[40:43], s63 offen sc1
    buffer_store_dwordx4 v[36:39], v17, s[40:43], s64 offen sc1
    v_dot2c_f32_bf16 v40, v32, v32
    v_dot2c_f32_bf16 v41, v36, v36
    v_dot2c_f32_bf16 v40, v33, v33
    v_dot2c_f32_bf16 v41, v37, v37
    v_dot2c_f32_bf16 v40, v34, v34
    v_dot2c_f32_bf16 v41, v38, v38
    v_dot2c_f32_bf16 v40, v35, v35
    v_dot2c_f32_bf16 v41, v39, v39
    v_pk_mul_f32 v[48:49], v[48:49], v[18:19] op_sel_hi:[1,0]
    v_pk_mul_f32 v[50:51], v[50:51], v[18:19] op_sel_hi:[1,0]
    v_pk_mul_f32 v[52:53], v[52:53], v[18:19] op_sel_hi:[1,0]
    v_pk_mul_f32 v[54:55], v[54:55], v[18:19] op_sel_hi:[1,0]
    v_max3_f32 v28, v40, v41, v28
    v_pk_mul_f32 v[56:57], v[56:57], v[18:19] op_sel_hi:[1,0]
    v_pk_mul_f32 v[58:59], v[58:59], v[18:19] op_sel_hi:[1,0]
    v_pk_mul_f32 v[60:61], v[60:61], v[18:19] op_sel_hi:[1,0]
    v_pk_mul_f32 v[62:63], v[62:63], v[18:19] op_sel_hi:[1,0]
    v_cvt_pk_bf16_f32 v48, v48, v49
    v_cvt_pk_bf16_f32 v49, v50, v51
    v_cvt_pk_bf16_f32 v50, v52, v53
    v_cvt_pk_bf16_f32 v51, v54, v55
    s_add_u32 s63, s86, 131072
    s_add_u32 s64, s86, 196608
    v_cvt_pk_bf16_f32 v52, v56, v57
    v_cvt_pk_bf16_f32 v53, v58, v59
    v_cvt_pk_bf16_f32 v54, v60, v61
    v_cvt_pk_bf16_f32 v55, v62, v63
    v_mov_b32 v56, 0
    v_mov_b32 v57, 0
    buffer_store_dwordx4 v[48:51], v17, s[40:43], s63 offen sc1
    buffer_store_dwordx4 v[52:55], v17, s[40:43], s64 offen sc1
    v_dot2c_f32_bf16 v56, v48, v48
    v_dot2c_f32_bf16 v57, v52, v52
    v_dot2c_f32_bf16 v56, v49, v49
    v_dot2c_f32_bf16 v57, v53, v53
    v_dot2c_f32_bf16 v56, v50, v50
    v_dot2c_f32_bf16 v57, v54, v54
    v_dot2c_f32_bf16 v56, v51, v51
    v_dot2c_f32_bf16 v57, v55, v55
    s_add_u32 s65, s85, 4
    s_lshr_b32 s62, s65, 3
    s_and_b32 s63, s65, 7
    s_lshl_b32 s63, s63, 18
    v_max3_f32 v28, v56, v57, v28
    s_lshl_b32 s64, s62, 21
    s_add_u32 s63, s63, s64
    s_add_u32 s86, s63, s83
    s_cmp_eq_u32 s62, 0
    s_cselect_b32 s82, 0x3eb8aa3b, 1.0
    s_cmp_eq_u32 s62, 2
    s_cselect_b64 s[80:81], -1, 0
    v_mul_f32 v18, s82, v25
    v_cndmask_b32 v17, v30, v31, s[80:81]
    v_pk_mul_f32 v[64:65], v[64:65], v[18:19] op_sel_hi:[1,0]
    v_pk_mul_f32 v[66:67], v[66:67], v[18:19] op_sel_hi:[1,0]
    v_pk_mul_f32 v[68:69], v[68:69], v[18:19] op_sel_hi:[1,0]
    v_pk_mul_f32 v[70:71], v[70:71], v[18:19] op_sel_hi:[1,0]
    v_pk_mul_f32 v[72:73], v[72:73], v[18:19] op_sel_hi:[1,0]
    v_pk_mul_f32 v[74:75], v[74:75], v[18:19] op_sel_hi:[1,0]
    v_pk_mul_f32 v[76:77], v[76:77], v[18:19] op_sel_hi:[1,0]
    v_pk_mul_f32 v[78:79], v[78:79], v[18:19] op_sel_hi:[1,0]
    v_cvt_pk_bf16_f32 v64, v64, v65
    v_cvt_pk_bf16_f32 v65, v66, v67
    v_cvt_pk_bf16_f32 v66, v68, v69
    v_cvt_pk_bf16_f32 v67, v70, v71
    s_add_u32 s63, s86, 0
    s_add_u32 s64, s86, 65536
    v_cvt_pk_bf16_f32 v68, v72, v73
    v_cvt_pk_bf16_f32 v69, v74, v75
    v_cvt_pk_bf16_f32 v70, v76, v77
    v_cvt_pk_bf16_f32 v71, v78, v79
    v_mov_b32 v72, 0
    v_mov_b32 v73, 0
    buffer_store_dwordx4 v[64:67], v17, s[40:43], s63 offen sc1
    buffer_store_dwordx4 v[68:71], v17, s[40:43], s64 offen sc1
    v_dot2c_f32_bf16 v72, v64, v64
    v_dot2c_f32_bf16 v73, v68, v68
    v_dot2c_f32_bf16 v72, v65, v65
    v_dot2c_f32_bf16 v73, v69, v69
    v_dot2c_f32_bf16 v72, v66, v66
    v_dot2c_f32_bf16 v73, v70, v70
    v_dot2c_f32_bf16 v72, v67, v67
    v_dot2c_f32_bf16 v73, v71, v71
    v_pk_mul_f32 v[80:81], v[80:81], v[18:19] op_sel_hi:[1,0]
    v_pk_mul_f32 v[82:83], v[82:83], v[18:19] op_sel_hi:[1,0]
    v_pk_mul_f32 v[84:85], v[84:85], v[18:19] op_sel_hi:[1,0]
    v_pk_mul_f32 v[86:87], v[86:87], v[18:19] op_sel_hi:[1,0]
    v_max3_f32 v28, v72, v73, v28
    v_pk_mul_f32 v[88:89], v[88:89], v[18:19] op_sel_hi:[1,0]
    v_pk_mul_f32 v[90:91], v[90:91], v[18:19] op_sel_hi:[1,0]
    v_pk_mul_f32 v[92:93], v[92:93], v[18:19] op_sel_hi:[1,0]
    v_pk_mul_f32 v[94:95], v[94:95], v[18:19] op_sel_hi:[1,0]
    v_cvt_pk_bf16_f32 v80, v80, v81
    v_cvt_pk_bf16_f32 v81, v82, v83
    v_cvt_pk_bf16_f32 v82, v84, v85
    v_cvt_pk_bf16_f32 v83, v86, v87
    s_add_u32 s63, s86, 131072
    s_add_u32 s64, s86, 196608
    v_cvt_pk_bf16_f32 v84, v88, v89
    v_cvt_pk_bf16_f32 v85, v90, v91
    v_cvt_pk_bf16_f32 v86, v92, v93
    v_cvt_pk_bf16_f32 v87, v94, v95
    v_mov_b32 v88, 0
    v_mov_b32 v89, 0
    buffer_store_dwordx4 v[80:83], v17, s[40:43], s63 offen sc1
    buffer_store_dwordx4 v[84:87], v17, s[40:43], s64 offen sc1
    v_dot2c_f32_bf16 v88, v80, v80
    v_dot2c_f32_bf16 v89, v84, v84
    v_dot2c_f32_bf16 v88, v81, v81
    v_dot2c_f32_bf16 v89, v85, v85
    v_dot2c_f32_bf16 v88, v82, v82
    v_dot2c_f32_bf16 v89, v86, v86
    v_dot2c_f32_bf16 v88, v83, v83
    v_dot2c_f32_bf16 v89, v87, v87
    s_nop 2
    v_max3_f32 v28, v88, v89, v28
.Lk1_epi_done:
    s_nop 1
    v_max_f32_dpp v28, v28, v28 row_shr:1 row_mask:0xf bank_mask:0xf
    s_nop 1
    v_max_f32_dpp v28, v28, v28 row_shr:2 row_mask:0xf bank_mask:0xf
    s_nop 1
    v_max_f32_dpp v28, v28, v28 row_shr:4 row_mask:0xf bank_mask:0xf
    s_nop 1
    v_max_f32_dpp v28, v28, v28 row_shr:8 row_mask:0xf bank_mask:0xf
    s_nop 1
    v_max_f32_dpp v28, v28, v28 row_bcast:15 row_mask:0xa bank_mask:0xf
    s_nop 1
    v_max_f32_dpp v28, v28, v28 row_bcast:31 row_mask:0xc bank_mask:0xf
    s_lshl_b32 s62, s56, 9
    s_lshl_b32 s63, s57, 2
    s_add_u32 s62, s62, s63
    s_add_u32 s62, s62, 18874368
    v_mov_b32 v1, 0
    v_and_b32 v3, 63, v0
    v_cmp_eq_u32 vcc, 63, v3
    s_nop 3
    s_and_saveexec_b64 s[86:87], vcc
    buffer_store_dword v28, v1, s[40:43], s62 offen
    buffer_store_dword v28, v1, s[40:43], s62 offen offset:256
.Lk1_end:
    s_endpgm
.section .rodata,"a"
.p2align 6
.amdhsa_kernel k1_kernel
  .amdhsa_next_free_vgpr 400
  .amdhsa_next_free_sgpr 102
  .amdhsa_accum_offset 256
  .amdhsa_group_segment_fixed_size 0
  .amdhsa_kernarg_size 80
  .amdhsa_user_sgpr_count 2
  .amdhsa_user_sgpr_kernarg_segment_ptr 1
  .amdhsa_system_sgpr_workgroup_id_x 1
  .amdhsa_float_denorm_mode_32 3
.end_amdhsa_kernel
.text
.globl k2_kernel
.p2align 8
.type k2_kernel,@function
k2_kernel:
    s_cmp_ge_u32 s2, 256
    s_cbranch_scc1 .Lk2_end
    s_load_dwordx2 s[4:5], s[0:1], 72
    s_load_dwordx2 s[6:7], s[0:1], 48
    s_load_dwordx2 s[8:9], s[0:1], 16
    s_load_dwordx2 s[10:11], s[0:1], 0
    s_load_dwordx2 s[12:13], s[0:1], 56
    v_lshrrev_b32 v2, 6, v0
    v_and_b32 v3, 63, v0
    v_readfirstlane_b32 s24, v2
    v_lshlrev_b32 v1, 4, v0
    s_and_b32 s27, s2, 7
    s_lshr_b32 s28, s2, 3
    s_lshr_b32 s25, s28, 3
    s_lshl_b32 s29, s27, 2
    s_add_u32 s25, s25, s29
    s_and_b32 s26, s28, 7
    s_lshl_b32 s26, s26, 3
    s_and_b32 s33, s28, 3
    s_add_u32 s33, s33, s29
    s_lshr_b32 s34, s28, 2
    v_lshlrev_b32 v143, 4, v3
    v_lshrrev_b32 v20, 5, v3
    v_bfe_u32 v21, v3, 4, 1
    v_bfe_u32 v22, v3, 2, 2
    v_and_b32 v23, 3, v3
    s_waitcnt lgkmcnt(0)
    s_mov_b32 s16, s4
    s_mov_b32 s17, s5
    s_mov_b32 s18, 268435456
    s_mov_b32 s19, 131072
    s_mov_b32 s20, s6
    s_mov_b32 s21, s7
    s_mov_b32 s22, 1835008
    s_mov_b32 s23, 131072
    s_cmp_ge_u32 s24, 8
    s_cbranch_scc1 .Lk2_gemm
    s_and_b32 s44, s24, 3
    s_lshr_b32 s45, s24, 2
    s_lshl_b32 s28, s44, 1
    s_add_u32 s26, s26, s28
    s_lshl_b32 s27, s25, 16
    s_lshl_b32 s28, s26, 10
    s_add_u32 s28, s28, s27
    buffer_load_dwordx4 v[4:7], v143, s[16:19], s28 offen
    buffer_load_dwordx4 v[8:11], v143, s[16:19], s28 offen offset:1024
    s_lshr_b32 s28, s25, 2
    s_add_u32 s29, s28, 8
    s_min_u32 s29, s29, 14
    s_lshl_b32 s29, s29, 9
    s_add_u32 s29, s29, 18874368
    s_cmp_ge_u32 s28, 3
    s_cselect_b32 s30, 15, 14
    s_lshl_b32 s30, s30, 9
    s_add_u32 s30, s30, 18874624
    v_lshlrev_b32 v12, 2, v3
    buffer_load_dword v144, v12, s[16:19], s29 offen
    buffer_load_dword v145, v12, s[16:19], s30 offen
    s_and_b32 s28, s44, 1
    s_mul_i32 s28, s28, 5
    s_lshl_b32 s29, s45, 5
    s_add_u32 s28, s28, s29
    s_lshl_b32 s28, s28, 10
    s_lshr_b32 s29, s44, 1
    s_lshl_b32 s30, s29, 16
    s_add_u32 s30, s30, s28
    s_lshl_b32 s29, s29, 21
    s_add_u32 s28, s28, s29
    s_add_u32 s28, s28, s27
    s_add_u32 s28, s28, 2097152
    s_add_u32 m0, s30, 0
    s_add_u32 s46, s28, 0
    buffer_load_dwordx4 v143, s[16:19], s46 offen offset:0 lds
    buffer_load_dwordx4 v143, s[16:19], s46 offen offset:1024 lds
    buffer_load_dwordx4 v143, s[16:19], s46 offen offset:2048 lds
    buffer_load_dwordx4 v143, s[16:19], s46 offen offset:3072 lds
    s_add_u32 m0, s30, 4096
    s_add_u32 s46, s28, 4096
    buffer_load_dwordx4 v143, s[16:19], s46 offen offset:0 lds
    v_and_b32 v12, 1, v3
    v_cmp_eq_u32 vcc, 0, v12
    v_mov_b32 v13, 0x3f80
    s_nop 0
    v_cndmask_b32 v12, 0, v13, vcc
    v_mov_b32 v13, 0
    v_mov_b32 v14, 0
    v_mov_b32 v15, 0
    s_lshl_b32 s28, s24, 10
    s_min_u32 s28, s28, 4096
    s_add_u32 s28, s28, 131072
    v_add_u32 v1, s28, v143
    ds_write_b128 v1, v[12:15]
    s_lshl_b32 s28, s45, 15
    v_add_u32 v140, s28, v143
    v_lshlrev_b32 v1, 5, v22
    v_lshl_add_u32 v1, v23, 3, v1
    v_lshl_add_u32 v2, v20, 7, v1
    s_add_u32 s28, s28, 65536
    v_add_u32 v2, s28, v2
    v_xor_b32 v12, 1, v20
    v_min_u32 v13, 1, v23
    v_lshlrev_b32 v13, 3, v13
    v_lshl_add_u32 v12, v12, 7, v13
    v_add_u32 v12, 131072, v12
    v_cmp_eq_u32 vcc, 0, v21
    s_nop 1
    v_cndmask_b32 v141, v12, v2, vcc
    v_mov_b32 v12, 0x1000
    v_cndmask_b32 v142, 0, v12, vcc
    v_mov_b32 v44, 0
    v_mov_b32 v45, 0
    v_mov_b32 v46, 0
    v_mov_b32 v47, 0
    v_mov_b32 v48, 0
    v_mov_b32 v49, 0
    v_mov_b32 v50, 0
    v_mov_b32 v51, 0
    v_mov_b32 v52, 0
    v_mov_b32 v53, 0
    v_mov_b32 v54, 0
    v_mov_b32 v55, 0
    v_mov_b32 v56, 0
    v_mov_b32 v57, 0
    v_mov_b32 v58, 0
    v_mov_b32 v59, 0
    v_mov_b32 v60, 0
    v_mov_b32 v61, 0
    v_mov_b32 v62, 0
    v_mov_b32 v63, 0
    v_mov_b32 v64, 0
    v_mov_b32 v65, 0
    v_mov_b32 v66, 0
    v_mov_b32 v67, 0
    v_mov_b32 v68, 0
    v_mov_b32 v69, 0
    v_mov_b32 v70, 0
    v_mov_b32 v71, 0
    v_mov_b32 v72, 0
    v_mov_b32 v73, 0
    v_mov_b32 v74, 0
    v_mov_b32 v75, 0
    s_waitcnt vmcnt(5)
    v_max_f32_dpp v144, v144, v144 row_shr:1 row_mask:0xf bank_mask:0xf
    v_max_f32_dpp v145, v145, v145 row_shr:1 row_mask:0xf bank_mask:0xf
    s_nop 0
    v_max_f32_dpp v144, v144, v144 row_shr:2 row_mask:0xf bank_mask:0xf
    v_max_f32_dpp v145, v145, v145 row_shr:2 row_mask:0xf bank_mask:0xf
    s_nop 0
    v_max_f32_dpp v144, v144, v144 row_shr:4 row_mask:0xf bank_mask:0xf
    v_max_f32_dpp v145, v145, v145 row_shr:4 row_mask:0xf bank_mask:0xf
    s_nop 0
    v_max_f32_dpp v144, v144, v144 row_shr:8 row_mask:0xf bank_mask:0xf
    v_max_f32_dpp v145, v145, v145 row_shr:8 row_mask:0xf bank_mask:0xf
    s_nop 0
    v_max_f32_dpp v144, v144, v144 row_bcast:15 row_mask:0xa bank_mask:0xf
    v_max_f32_dpp v145, v145, v145 row_bcast:15 row_mask:0xa bank_mask:0xf
    s_nop 0
    v_max_f32_dpp v144, v144, v144 row_bcast:31 row_mask:0xc bank_mask:0xf
    v_max_f32_dpp v145, v145, v145 row_bcast:31 row_mask:0xc bank_mask:0xf
    v_mov_b32 v146, 0
    v_mov_b32 v148, 0
    v_dot2c_f32_bf16 v146, v4, v4
    v_dot2c_f32_bf16 v148, v8, v8
    v_dot2c_f32_bf16 v146, v5, v5
    v_dot2c_f32_bf16 v148, v9, v9
    v_dot2c_f32_bf16 v146, v6, v6
    v_dot2c_f32_bf16 v148, v10, v10
    v_dot2c_f32_bf16 v146, v7, v7
    v_dot2c_f32_bf16 v148, v11, v11
    v_readlane_b32 s40, v144, 63
    v_readlane_b32 s41, v145, 63
    s_nop 0
    v_max_f32 v146, v146, v148
    v_mov_b32 v147, v146
    s_nop 1
    v_permlane32_swap_b32 v146, v147
    v_add_f32 v146, v146, v147
    v_mul_f32 v146, s40, v146
    v_mov_b32 v147, 0x45000000
    v_cmp_nle_f32 vcc, v146, v147
    s_nop 3
    s_mov_b64 s[42:43], vcc
    v_mov_b32 v146, s41
    v_mov_b32 v147, 0x71000000
    v_cmp_nle_f32 vcc, v146, v147
    s_nop 3
    s_or_b64 s[42:43], s[42:43], vcc
    s_cmp_lg_u64 s[42:43], 0
    s_cselect_b32 s39, 1, 0
    s_waitcnt vmcnt(0) lgkmcnt(0)
    s_barrier
    s_cmp_eq_u32 s39, 0
    s_cbranch_scc1 .Lk2_fast
    s_barrier
    v_mov_b32 v144, 0xff800000
    v_mov_b32 v145, 0xff800000
    v_mov_b32 v146, v143
    s_mov_b32 s31, 0
.Lk2_max:
    ds_read_b128 v[12:15], v146
    v_add_u32 v146, 0x400, v146
    s_waitcnt lgkmcnt(0)
    v_mfma_f32_32x32x16_bf16 v[76:91], v[12:15], v[4:7], 0
    v_mfma_f32_32x32x16_bf16 v[92:107], v[12:15], v[8:11], 0
    s_nop 10
    v_max3_f32 v144, v76, v77, v144
    v_max3_f32 v144, v78, v79, v144
    v_max3_f32 v144, v80, v81, v144
    v_max3_f32 v144, v82, v83, v144
    v_max3_f32 v144, v84, v85, v144
    v_max3_f32 v144, v86, v87, v144
    v_max3_f32 v144, v88, v89, v144
    v_max3_f32 v144, v90, v91, v144
    v_max3_f32 v145, v92, v93, v145
    v_max3_f32 v145, v94, v95, v145
    v_max3_f32 v145, v96, v97, v145
    v_max3_f32 v145, v98, v99, v145
    v_max3_f32 v145, v100, v101, v145
    v_max3_f32 v145, v102, v103, v145
    v_max3_f32 v145, v104, v105, v145
    v_max3_f32 v145, v106, v107, v145
    s_add_u32 s31, s31, 1
    s_cmp_lt_u32 s31, 64
    s_cbranch_scc1 .Lk2_max
    v_mov_b32 v147, v144
    s_nop 1
    v_permlane32_swap_b32 v144, v147
    v_max_f32 v144, v144, v147
    v_sub_f32 v108, 0, v144
    v_sub_f32 v109, 0, v144
    v_sub_f32 v110, 0, v144
    v_sub_f32 v111, 0, v144
    v_sub_f32 v112, 0, v144
    v_sub_f32 v113, 0, v144
    v_sub_f32 v114, 0, v144
    v_sub_f32 v115, 0, v144
    v_sub_f32 v116, 0, v144
    v_sub_f32 v117, 0, v144
    v_sub_f32 v118, 0, v144
    v_sub_f32 v119, 0, v144
    v_sub_f32 v120, 0, v144
    v_sub_f32 v121, 0, v144
    v_sub_f32 v122, 0, v144
    v_sub_f32 v123, 0, v144
    v_mov_b32 v147, v145
    s_nop 1
    v_permlane32_swap_b32 v145, v147
    v_max_f32 v145, v145, v147
    v_sub_f32 v124, 0, v145
    v_sub_f32 v125, 0, v145
    v_sub_f32 v126, 0, v145
    v_sub_f32 v127, 0, v145
    v_sub_f32 v128, 0, v145
    v_sub_f32 v129, 0, v145
    v_sub_f32 v130, 0, v145
    v_sub_f32 v131, 0, v145
    v_sub_f32 v132, 0, v145
    v_sub_f32 v133, 0, v145
    v_sub_f32 v134, 0, v145
    v_sub_f32 v135, 0, v145
    v_sub_f32 v136, 0, v145
    v_sub_f32 v137, 0, v145
    v_sub_f32 v138, 0, v145
    v_sub_f32 v139, 0, v145
    ds_read_b128 v[12:15], v140 offset:0
    ds_read_b64_tr_b16 v[20:21], v141 offset:0
    ds_read_b64_tr_b16 v[22:23], v141 offset:256
    ds_read_b64_tr_b16 v[24:25], v141 offset:512
    ds_read_b64_tr_b16 v[26:27], v141 offset:768
    s_waitcnt lgkmcnt(0)
    v_mfma_f32_32x32x16_bf16 v[76:91], v[12:15], v[4:7], v[108:123]
    s_mov_b32 s31, 0
    s_nop 10
    v_exp_f32 v76, v76
    v_exp_f32 v77, v77
    v_exp_f32 v78, v78
    .p2align 3
.Lk2_loopF:
    v_cvt_pk_bf16_f32 v36, v76, v77
    v_exp_f32 v79, v79
    v_exp_f32 v80, v80
    v_cvt_pk_bf16_f32 v37, v78, v79
    v_exp_f32 v81, v81
    v_exp_f32 v82, v82
    v_mfma_f32_32x32x16_bf16 v[92:107], v[12:15], v[8:11], v[124:139]
    ds_read_b128 v[16:19], v140 offset:1024
    ds_read_b64_tr_b16 v[28:29], v141 offset:1024
    ds_read_b64_tr_b16 v[30:31], v141 offset:1280
    v_cvt_pk_bf16_f32 v38, v80, v81
    v_exp_f32 v83, v83
    v_exp_f32 v84, v84
    v_cvt_pk_bf16_f32 v39, v82, v83
    v_exp_f32 v85, v85
    v_exp_f32 v86, v86
    v_mfma_f32_32x32x16_bf16 v[44:59], v[20:23], v[36:39], v[44:59]
    ds_read_b64_tr_b16 v[32:33], v141 offset:1536
    ds_read_b64_tr_b16 v[34:35], v141 offset:1792
    v_cvt_pk_bf16_f32 v40, v84, v85
    v_exp_f32 v87, v87
    v_exp_f32 v88, v88
    v_cvt_pk_bf16_f32 v41, v86, v87
    v_exp_f32 v89, v89
    v_exp_f32 v90, v90
    v_cvt_pk_bf16_f32 v42, v88, v89
    v_exp_f32 v91, v91
    v_exp_f32 v92, v92
    v_cvt_pk_bf16_f32 v43, v90, v91
    v_exp_f32 v93, v93
    v_exp_f32 v94, v94
    v_mfma_f32_32x32x16_bf16 v[44:59], v[24:27], v[40:43], v[44:59]
    v_cvt_pk_bf16_f32 v36, v92, v93
    v_exp_f32 v95, v95
    v_exp_f32 v96, v96
    v_cvt_pk_bf16_f32 v37, v94, v95
    v_exp_f32 v97, v97
    s_waitcnt lgkmcnt(0)
    v_exp_f32_e64 v98, v98
    v_mfma_f32_32x32x16_bf16 v[76:91], v[16:19], v[4:7], v[108:123]
    v_cvt_pk_bf16_f32 v38, v96, v97
    v_exp_f32 v99, v99
    v_exp_f32 v100, v100
    v_cvt_pk_bf16_f32 v39, v98, v99
    v_exp_f32 v101, v101
    v_exp_f32 v102, v102
    v_mfma_f32_32x32x16_bf16 v[60:75], v[20:23], v[36:39], v[60:75]
    v_cvt_pk_bf16_f32 v40, v100, v101
    v_exp_f32 v103, v103
    v_exp_f32 v104, v104
    v_cvt_pk_bf16_f32 v41, v102, v103
    v_exp_f32 v105, v105
    v_exp_f32 v106, v106
    v_cvt_pk_bf16_f32 v42, v104, v105
    v_exp_f32 v107, v107
    v_exp_f32 v76, v76
    v_cvt_pk_bf16_f32 v43, v106, v107
    v_exp_f32 v77, v77
    v_exp_f32 v78, v78
    v_mfma_f32_32x32x16_bf16 v[60:75], v[24:27], v[40:43], v[60:75]
    v_cvt_pk_bf16_f32 v36, v76, v77
    v_exp_f32 v79, v79
    v_exp_f32 v80, v80
    v_cvt_pk_bf16_f32 v37, v78, v79
    v_exp_f32 v81, v81
    v_exp_f32 v82, v82
    v_mfma_f32_32x32x16_bf16 v[92:107], v[16:19], v[8:11], v[124:139]
    ds_read_b128 v[12:15], v140 offset:2048
    ds_read_b64_tr_b16 v[20:21], v141 offset:2048
    ds_read_b64_tr_b16 v[22:23], v141 offset:2304
    v_cvt_pk_bf16_f32 v38, v80, v81
    v_exp_f32 v83, v83
    v_exp_f32 v84, v84
    v_cvt_pk_bf16_f32 v39, v82, v83
    v_exp_f32 v85, v85
    v_exp_f32 v86, v86
    v_mfma_f32_32x32x16_bf16 v[44:59], v[28:31], v[36:39], v[44:59]
    ds_read_b64_tr_b16 v[24:25], v141 offset:2560
    ds_read_b64_tr_b16 v[26:27], v141 offset:2816
    v_cvt_pk_bf16_f32 v40, v84, v85
    v_exp_f32 v87, v87
    v_exp_f32 v88, v88
    v_cvt_pk_bf16_f32 v41, v86, v87
    v_exp_f32 v89, v89
    v_exp_f32 v90, v90
    v_cvt_pk_bf16_f32 v42, v88, v89
    v_exp_f32 v91, v91
    v_exp_f32 v92, v92
    v_cvt_pk_bf16_f32 v43, v90, v91
    v_exp_f32 v93, v93
    v_exp_f32 v94, v94
    v_mfma_f32_32x32x16_bf16 v[44:59], v[32:35], v[40:43], v[44:59]
    v_cvt_pk_bf16_f32 v36, v92, v93
    v_exp_f32 v95, v95
    v_exp_f32 v96, v96
    v_cvt_pk_bf16_f32 v37, v94, v95
    v_exp_f32 v97, v97
    s_waitcnt lgkmcnt(0)
    v_exp_f32_e64 v98, v98
    v_mfma_f32_32x32x16_bf16 v[76:91], v[12:15], v[4:7], v[108:123]
    v_cvt_pk_bf16_f32 v38, v96, v97
    v_exp_f32 v99, v99
    v_exp_f32 v100, v100
    v_cvt_pk_bf16_f32 v39, v98, v99
    v_exp_f32 v101, v101
    v_exp_f32 v102, v102
    v_mfma_f32_32x32x16_bf16 v[60:75], v[28:31], v[36:39], v[60:75]
    v_cvt_pk_bf16_f32 v40, v100, v101
    v_exp_f32 v103, v103
    v_exp_f32 v104, v104
    v_cvt_pk_bf16_f32 v41, v102, v103
    v_exp_f32 v105, v105
    v_exp_f32 v106, v106
    v_cvt_pk_bf16_f32 v42, v104, v105
    v_exp_f32 v107, v107
    v_exp_f32 v76, v76
    v_cvt_pk_bf16_f32 v43, v106, v107
    v_exp_f32 v77, v77
    v_exp_f32 v78, v78
    v_mfma_f32_32x32x16_bf16 v[60:75], v[32:35], v[40:43], v[60:75]
    v_cvt_pk_bf16_f32 v36, v76, v77
    v_exp_f32 v79, v79
    v_exp_f32 v80, v80
    v_cvt_pk_bf16_f32 v37, v78, v79
    v_exp_f32 v81, v81
    v_exp_f32 v82, v82
    v_mfma_f32_32x32x16_bf16 v[92:107], v[12:15], v[8:11], v[124:139]
    ds_read_b128 v[16:19], v140 offset:3072
    ds_read_b64_tr_b16 v[28:29], v141 offset:3072
    ds_read_b64_tr_b16 v[30:31], v141 offset:3328
    v_cvt_pk_bf16_f32 v38, v80, v81
    v_exp_f32 v83, v83
    v_exp_f32 v84, v84
    v_cvt_pk_bf16_f32 v39, v82, v83
    v_exp_f32 v85, v85
    v_exp_f32 v86, v86
    v_mfma_f32_32x32x16_bf16 v[44:59], v[20:23], v[36:39], v[44:59]
    ds_read_b64_tr_b16 v[32:33], v141 offset:3584
    ds_read_b64_tr_b16 v[34:35], v141 offset:3840
    v_cvt_pk_bf16_f32 v40, v84, v85
    v_exp_f32 v87, v87
    v_exp_f32 v88, v88
    v_cvt_pk_bf16_f32 v41, v86, v87
    v_exp_f32 v89, v89
    v_exp_f32 v90, v90
    v_cvt_pk_bf16_f32 v42, v88, v89
    v_exp_f32 v91, v91
    v_exp_f32 v92, v92
    v_cvt_pk_bf16_f32 v43, v90, v91
    v_exp_f32 v93, v93
    v_exp_f32 v94, v94
    v_mfma_f32_32x32x16_bf16 v[44:59], v[24:27], v[40:43], v[44:59]
    v_cvt_pk_bf16_f32 v36, v92, v93
    v_exp_f32 v95, v95
    v_exp_f32 v96, v96
    v_cvt_pk_bf16_f32 v37, v94, v95
    v_exp_f32 v97, v97
    s_waitcnt lgkmcnt(0)
    v_exp_f32_e64 v98, v98
    v_mfma_f32_32x32x16_bf16 v[76:91], v[16:19], v[4:7], v[108:123]
    v_cvt_pk_bf16_f32 v38, v96, v97
    v_exp_f32 v99, v99
    v_exp_f32 v100, v100
    v_cvt_pk_bf16_f32 v39, v98, v99
    v_exp_f32 v101, v101
    v_exp_f32 v102, v102
    v_mfma_f32_32x32x16_bf16 v[60:75], v[20:23], v[36:39], v[60:75]
    v_cvt_pk_bf16_f32 v40, v100, v101
    v_exp_f32 v103, v103
    v_exp_f32 v104, v104
    v_cvt_pk_bf16_f32 v41, v102, v103
    v_exp_f32 v105, v105
    v_exp_f32 v106, v106
    v_cvt_pk_bf16_f32 v42, v104, v105
    v_exp_f32 v107, v107
    v_exp_f32 v76, v76
    v_cvt_pk_bf16_f32 v43, v106, v107
    v_exp_f32 v77, v77
    v_exp_f32 v78, v78
    v_mfma_f32_32x32x16_bf16 v[60:75], v[24:27], v[40:43], v[60:75]
    v_cvt_pk_bf16_f32 v36, v76, v77
    v_exp_f32 v79, v79
    v_exp_f32 v80, v80
    v_cvt_pk_bf16_f32 v37, v78, v79
    v_exp_f32 v81, v81
    v_exp_f32 v82, v82
    v_mfma_f32_32x32x16_bf16 v[92:107], v[16:19], v[8:11], v[124:139]
    ds_read_b128 v[12:15], v140 offset:4096
    ds_read_b64_tr_b16 v[20:21], v141 offset:4096
    ds_read_b64_tr_b16 v[22:23], v141 offset:4352
    v_cvt_pk_bf16_f32 v38, v80, v81
    v_exp_f32 v83, v83
    v_exp_f32 v84, v84
    v_cvt_pk_bf16_f32 v39, v82, v83
    v_exp_f32 v85, v85
    v_exp_f32 v86, v86
    v_mfma_f32_32x32x16_bf16 v[44:59], v[28:31], v[36:39], v[44:59]
    ds_read_b64_tr_b16 v[24:25], v141 offset:4608
    ds_read_b64_tr_b16 v[26:27], v141 offset:4864
    v_cvt_pk_bf16_f32 v40, v84, v85
    v_exp_f32 v87, v87
    v_exp_f32 v88, v88
    v_cvt_pk_bf16_f32 v41, v86, v87
    v_exp_f32 v89, v89
    v_exp_f32 v90, v90
    v_cvt_pk_bf16_f32 v42, v88, v89
    v_exp_f32 v91, v91
    v_exp_f32 v92, v92
    v_cvt_pk_bf16_f32 v43, v90, v91
    v_exp_f32 v93, v93
    v_exp_f32 v94, v94
    v_mfma_f32_32x32x16_bf16 v[44:59], v[32:35], v[40:43], v[44:59]
    v_cvt_pk_bf16_f32 v36, v92, v93
    v_exp_f32 v95, v95
    v_exp_f32 v96, v96
    v_cvt_pk_bf16_f32 v37, v94, v95
    v_exp_f32 v97, v97
    s_waitcnt lgkmcnt(0)
    v_exp_f32_e64 v98, v98
    v_mfma_f32_32x32x16_bf16 v[76:91], v[12:15], v[4:7], v[108:123]
    v_cvt_pk_bf16_f32 v38, v96, v97
    v_exp_f32 v99, v99
    v_exp_f32 v100, v100
    v_cvt_pk_bf16_f32 v39, v98, v99
    v_exp_f32 v101, v101
    v_exp_f32 v102, v102
    v_mfma_f32_32x32x16_bf16 v[60:75], v[28:31], v[36:39], v[60:75]
    v_cvt_pk_bf16_f32 v40, v100, v101
    v_exp_f32 v103, v103
    v_exp_f32 v104, v104
    v_cvt_pk_bf16_f32 v41, v102, v103
    v_exp_f32 v105, v105
    v_exp_f32 v106, v106
    v_cvt_pk_bf16_f32 v42, v104, v105
    v_exp_f32 v107, v107
    v_exp_f32 v76, v76
    v_cvt_pk_bf16_f32 v43, v106, v107
    v_exp_f32 v77, v77
    v_exp_f32 v78, v78
    v_mfma_f32_32x32x16_bf16 v[60:75], v[32:35], v[40:43], v[60:75]
    v_add_u32 v140, 0x1000, v140
    v_add_u32 v141, v142, v141
    s_add_u32 s31, s31, 1
    s_cmp_lt_u32 s31, 8
    s_cbranch_scc1 .Lk2_loopF
    s_branch .Lk2_done
.Lk2_fast:
    ds_read_b128 v[12:15], v140 offset:0
    ds_read_b64_tr_b16 v[20:21], v141 offset:0
    ds_read_b64_tr_b16 v[22:23], v141 offset:256
    ds_read_b64_tr_b16 v[24:25], v141 offset:512
    ds_read_b64_tr_b16 v[26:27], v141 offset:768
    s_waitcnt lgkmcnt(0)
    v_mfma_f32_32x32x16_bf16 v[76:91], v[12:15], v[4:7], 0
    s_mov_b32 s31, 0
    s_nop 10
    v_exp_f32 v76, v76
    v_exp_f32 v77, v77
    v_exp_f32 v78, v78
    .p2align 3
.Lk2_loop:
    v_cvt_pk_bf16_f32 v36, v76, v77
    v_exp_f32 v79, v79
    v_exp_f32 v80, v80
    v_cvt_pk_bf16_f32 v37, v78, v79
    v_exp_f32 v81, v81
    v_exp_f32 v82, v82
    v_mfma_f32_32x32x16_bf16 v[92:107], v[12:15], v[8:11], 0
    ds_read_b128 v[16:19], v140 offset:1024
    ds_read_b64_tr_b16 v[28:29], v141 offset:1024
    ds_read_b64_tr_b16 v[30:31], v141 offset:1280
    v_cvt_pk_bf16_f32 v38, v80, v81
    v_exp_f32 v83, v83
    v_exp_f32 v84, v84
    v_cvt_pk_bf16_f32 v39, v82, v83
    v_exp_f32 v85, v85
    v_exp_f32 v86, v86
    v_mfma_f32_32x32x16_bf16 v[44:59], v[20:23], v[36:39], v[44:59]
    ds_read_b64_tr_b16 v[32:33], v141 offset:1536
    ds_read_b64_tr_b16 v[34:35], v141 offset:1792
    v_cvt_pk_bf16_f32 v40, v84, v85
    v_exp_f32 v87, v87
    v_exp_f32 v88, v88
    v_cvt_pk_bf16_f32 v41, v86, v87
    v_exp_f32 v89, v89
    v_exp_f32 v90, v90
    v_cvt_pk_bf16_f32 v42, v88, v89
    v_exp_f32 v91, v91
    v_exp_f32 v92, v92
    v_cvt_pk_bf16_f32 v43, v90, v91
    v_exp_f32 v93, v93
    v_exp_f32 v94, v94
    v_mfma_f32_32x32x16_bf16 v[44:59], v[24:27], v[40:43], v[44:59]
    v_cvt_pk_bf16_f32 v36, v92, v93
    v_exp_f32 v95, v95
    v_exp_f32 v96, v96
    v_cvt_pk_bf16_f32 v37, v94, v95
    v_exp_f32 v97, v97
    s_waitcnt lgkmcnt(0)
    v_exp_f32_e64 v98, v98
    v_mfma_f32_32x32x16_bf16 v[76:91], v[16:19], v[4:7], 0
    v_cvt_pk_bf16_f32 v38, v96, v97
    v_exp_f32 v99, v99
    v_exp_f32 v100, v100
    v_cvt_pk_bf16_f32 v39, v98, v99
    v_exp_f32 v101, v101
    v_exp_f32 v102, v102
    v_mfma_f32_32x32x16_bf16 v[60:75], v[20:23], v[36:39], v[60:75]
    v_cvt_pk_bf16_f32 v40, v100, v101
    v_exp_f32 v103, v103
    v_exp_f32 v104, v104
    v_cvt_pk_bf16_f32 v41, v102, v103
    v_exp_f32 v105, v105
    v_exp_f32 v106, v106
    v_cvt_pk_bf16_f32 v42, v104, v105
    v_exp_f32 v107, v107
    v_exp_f32 v76, v76
    v_cvt_pk_bf16_f32 v43, v106, v107
    v_exp_f32 v77, v77
    v_exp_f32 v78, v78
    v_mfma_f32_32x32x16_bf16 v[60:75], v[24:27], v[40:43], v[60:75]
    v_cvt_pk_bf16_f32 v36, v76, v77
    v_exp_f32 v79, v79
    v_exp_f32 v80, v80
    v_cvt_pk_bf16_f32 v37, v78, v79
    v_exp_f32 v81, v81
    v_exp_f32 v82, v82
    v_mfma_f32_32x32x16_bf16 v[92:107], v[16:19], v[8:11], 0
    ds_read_b128 v[12:15], v140 offset:2048
    ds_read_b64_tr_b16 v[20:21], v141 offset:2048
    ds_read_b64_tr_b16 v[22:23], v141 offset:2304
    v_cvt_pk_bf16_f32 v38, v80, v81
    v_exp_f32 v83, v83
    v_exp_f32 v84, v84
    v_cvt_pk_bf16_f32 v39, v82, v83
    v_exp_f32 v85, v85
    v_exp_f32 v86, v86
    v_mfma_f32_32x32x16_bf16 v[44:59], v[28:31], v[36:39], v[44:59]
    ds_read_b64_tr_b16 v[24:25], v141 offset:2560
    ds_read_b64_tr_b16 v[26:27], v141 offset:2816
    v_cvt_pk_bf16_f32 v40, v84, v85
    v_exp_f32 v87, v87
    v_exp_f32 v88, v88
    v_cvt_pk_bf16_f32 v41, v86, v87
    v_exp_f32 v89, v89
    v_exp_f32 v90, v90
    v_cvt_pk_bf16_f32 v42, v88, v89
    v_exp_f32 v91, v91
    v_exp_f32 v92, v92
    v_cvt_pk_bf16_f32 v43, v90, v91
    v_exp_f32 v93, v93
    v_exp_f32 v94, v94
    v_mfma_f32_32x32x16_bf16 v[44:59], v[32:35], v[40:43], v[44:59]
    v_cvt_pk_bf16_f32 v36, v92, v93
    v_exp_f32 v95, v95
    v_exp_f32 v96, v96
    v_cvt_pk_bf16_f32 v37, v94, v95
    v_exp_f32 v97, v97
    s_waitcnt lgkmcnt(0)
    v_exp_f32_e64 v98, v98
    v_mfma_f32_32x32x16_bf16 v[76:91], v[12:15], v[4:7], 0
    v_cvt_pk_bf16_f32 v38, v96, v97
    v_exp_f32 v99, v99
    v_exp_f32 v100, v100
    v_cvt_pk_bf16_f32 v39, v98, v99
    v_exp_f32 v101, v101
    v_exp_f32 v102, v102
    v_mfma_f32_32x32x16_bf16 v[60:75], v[28:31], v[36:39], v[60:75]
    v_cvt_pk_bf16_f32 v40, v100, v101
    v_exp_f32 v103, v103
    v_exp_f32 v104, v104
    v_cvt_pk_bf16_f32 v41, v102, v103
    v_exp_f32 v105, v105
    v_exp_f32 v106, v106
    v_cvt_pk_bf16_f32 v42, v104, v105
    v_exp_f32 v107, v107
    v_exp_f32 v76, v76
    v_cvt_pk_bf16_f32 v43, v106, v107
    v_exp_f32 v77, v77
    v_exp_f32 v78, v78
    v_mfma_f32_32x32x16_bf16 v[60:75], v[32:35], v[40:43], v[60:75]
    v_cvt_pk_bf16_f32 v36, v76, v77
    v_exp_f32 v79, v79
    v_exp_f32 v80, v80
    v_cvt_pk_bf16_f32 v37, v78, v79
    v_exp_f32 v81, v81
    v_exp_f32 v82, v82
    v_mfma_f32_32x32x16_bf16 v[92:107], v[12:15], v[8:11], 0
    ds_read_b128 v[16:19], v140 offset:3072
    ds_read_b64_tr_b16 v[28:29], v141 offset:3072
    ds_read_b64_tr_b16 v[30:31], v141 offset:3328
    v_cvt_pk_bf16_f32 v38, v80, v81
    v_exp_f32 v83, v83
    v_exp_f32 v84, v84
    v_cvt_pk_bf16_f32 v39, v82, v83
    v_exp_f32 v85, v85
    v_exp_f32 v86, v86
    v_mfma_f32_32x32x16_bf16 v[44:59], v[20:23], v[36:39], v[44:59]
    ds_read_b64_tr_b16 v[32:33], v141 offset:3584
    ds_read_b64_tr_b16 v[34:35], v141 offset:3840
    v_cvt_pk_bf16_f32 v40, v84, v85
    v_exp_f32 v87, v87
    v_exp_f32 v88, v88
    v_cvt_pk_bf16_f32 v41, v86, v87
    v_exp_f32 v89, v89
    v_exp_f32 v90, v90
    v_cvt_pk_bf16_f32 v42, v88, v89
    v_exp_f32 v91, v91
    v_exp_f32 v92, v92
    v_cvt_pk_bf16_f32 v43, v90, v91
    v_exp_f32 v93, v93
    v_exp_f32 v94, v94
    v_mfma_f32_32x32x16_bf16 v[44:59], v[24:27], v[40:43], v[44:59]
    v_cvt_pk_bf16_f32 v36, v92, v93
    v_exp_f32 v95, v95
    v_exp_f32 v96, v96
    v_cvt_pk_bf16_f32 v37, v94, v95
    v_exp_f32 v97, v97
    s_waitcnt lgkmcnt(0)
    v_exp_f32_e64 v98, v98
    v_mfma_f32_32x32x16_bf16 v[76:91], v[16:19], v[4:7], 0
    v_cvt_pk_bf16_f32 v38, v96, v97
    v_exp_f32 v99, v99
    v_exp_f32 v100, v100
    v_cvt_pk_bf16_f32 v39, v98, v99
    v_exp_f32 v101, v101
    v_exp_f32 v102, v102
    v_mfma_f32_32x32x16_bf16 v[60:75], v[20:23], v[36:39], v[60:75]
    v_cvt_pk_bf16_f32 v40, v100, v101
    v_exp_f32 v103, v103
    v_exp_f32 v104, v104
    v_cvt_pk_bf16_f32 v41, v102, v103
    v_exp_f32 v105, v105
    v_exp_f32 v106, v106
    v_cvt_pk_bf16_f32 v42, v104, v105
    v_exp_f32 v107, v107
    v_exp_f32 v76, v76
    v_cvt_pk_bf16_f32 v43, v106, v107
    v_exp_f32 v77, v77
    v_exp_f32 v78, v78
    v_mfma_f32_32x32x16_bf16 v[60:75], v[24:27], v[40:43], v[60:75]
    v_cvt_pk_bf16_f32 v36, v76, v77
    v_exp_f32 v79, v79
    v_exp_f32 v80, v80
    v_cvt_pk_bf16_f32 v37, v78, v79
    v_exp_f32 v81, v81
    v_exp_f32 v82, v82
    v_mfma_f32_32x32x16_bf16 v[92:107], v[16:19], v[8:11], 0
    ds_read_b128 v[12:15], v140 offset:4096
    ds_read_b64_tr_b16 v[20:21], v141 offset:4096
    ds_read_b64_tr_b16 v[22:23], v141 offset:4352
    v_cvt_pk_bf16_f32 v38, v80, v81
    v_exp_f32 v83, v83
    v_exp_f32 v84, v84
    v_cvt_pk_bf16_f32 v39, v82, v83
    v_exp_f32 v85, v85
    v_exp_f32 v86, v86
    v_mfma_f32_32x32x16_bf16 v[44:59], v[28:31], v[36:39], v[44:59]
    ds_read_b64_tr_b16 v[24:25], v141 offset:4608
    ds_read_b64_tr_b16 v[26:27], v141 offset:4864
    v_cvt_pk_bf16_f32 v40, v84, v85
    v_exp_f32 v87, v87
    v_exp_f32 v88, v88
    v_cvt_pk_bf16_f32 v41, v86, v87
    v_exp_f32 v89, v89
    v_exp_f32 v90, v90
    v_cvt_pk_bf16_f32 v42, v88, v89
    v_exp_f32 v91, v91
    v_exp_f32 v92, v92
    v_cvt_pk_bf16_f32 v43, v90, v91
    v_exp_f32 v93, v93
    v_exp_f32 v94, v94
    v_mfma_f32_32x32x16_bf16 v[44:59], v[32:35], v[40:43], v[44:59]
    v_cvt_pk_bf16_f32 v36, v92, v93
    v_exp_f32 v95, v95
    v_exp_f32 v96, v96
    v_cvt_pk_bf16_f32 v37, v94, v95
    v_exp_f32 v97, v97
    s_waitcnt lgkmcnt(0)
    v_exp_f32_e64 v98, v98
    v_mfma_f32_32x32x16_bf16 v[76:91], v[12:15], v[4:7], 0
    v_cvt_pk_bf16_f32 v38, v96, v97
    v_exp_f32 v99, v99
    v_exp_f32 v100, v100
    v_cvt_pk_bf16_f32 v39, v98, v99
    v_exp_f32 v101, v101
    v_exp_f32 v102, v102
    v_mfma_f32_32x32x16_bf16 v[60:75], v[28:31], v[36:39], v[60:75]
    v_cvt_pk_bf16_f32 v40, v100, v101
    v_exp_f32 v103, v103
    v_exp_f32 v104, v104
    v_cvt_pk_bf16_f32 v41, v102, v103
    v_exp_f32 v105, v105
    v_exp_f32 v106, v106
    v_cvt_pk_bf16_f32 v42, v104, v105
    v_exp_f32 v107, v107
    v_exp_f32 v76, v76
    v_cvt_pk_bf16_f32 v43, v106, v107
    v_exp_f32 v77, v77
    v_exp_f32 v78, v78
    v_mfma_f32_32x32x16_bf16 v[60:75], v[32:35], v[40:43], v[60:75]
    v_add_u32 v140, 0x1000, v140
    v_add_u32 v141, v142, v141
    s_add_u32 s31, s31, 1
    s_cmp_eq_u32 s31, 2
    s_cbranch_scc1 .Lk2_barB
.Lk2_cont:
    s_cmp_lt_u32 s31, 8
    s_cbranch_scc1 .Lk2_loop
.Lk2_done:
    s_waitcnt lgkmcnt(0)
    s_barrier
    s_mul_i32 s27, s24, 3072
    v_add_u32 v1, s27, v143
    s_xor_b32 s28, s24, 4
    s_mul_i32 s28, s28, 3072
    v_add_u32 v2, s28, v143
    s_add_u32 s27, s26, s45
    s_lshl_b32 s27, s27, 5
    s_add_u32 s27, s27, s25
    s_lshl_b32 s27, s27, 10
    s_add_u32 s27, s27, 14680064
    s_cmp_eq_u32 s45, 0
    s_cbranch_scc1 .Lk2_fin0
    ds_write_b128 v1, v[44:47] offset:0
    ds_write_b128 v1, v[48:51] offset:1024
    ds_write_b128 v1, v[52:55] offset:2048
    s_waitcnt lgkmcnt(0)
    s_barrier
    ds_read_b128 v[76:79], v2 offset:0
    ds_read_b128 v[80:83], v2 offset:1024
    ds_read_b128 v[84:87], v2 offset:2048
    s_waitcnt lgkmcnt(0)
    v_add_f32 v68, v68, v84
    v_mov_b32 v145, v68
    v_add_f32 v60, v60, v76
    v_add_f32 v61, v61, v77
    v_permlane32_swap_b32 v68, v145
    v_add_f32 v62, v62, v78
    v_add_f32 v63, v63, v79
    v_add_f32 v64, v64, v80
    v_add_f32 v65, v65, v81
    v_add_f32 v66, v66, v82
    v_add_f32 v67, v67, v83
    v_rcp_f32 v144, v68
    s_nop 0
    v_mul_f32 v60, v60, v144
    v_mul_f32 v61, v61, v144
    v_mul_f32 v62, v62, v144
    v_mul_f32 v63, v63, v144
    v_mul_f32 v64, v64, v144
    v_mul_f32 v65, v65, v144
    v_mul_f32 v66, v66, v144
    v_mul_f32 v67, v67, v144
    v_cvt_pk_bf16_f32 v36, v60, v61
    v_cvt_pk_bf16_f32 v37, v62, v63
    v_cvt_pk_bf16_f32 v38, v64, v65
    v_cvt_pk_bf16_f32 v39, v66, v67
    s_branch .Lk2_fin1
.Lk2_fin0:
    ds_write_b128 v1, v[60:63] offset:0
    ds_write_b128 v1, v[64:67] offset:1024
    ds_write_b128 v1, v[68:71] offset:2048
    s_waitcnt lgkmcnt(0)
    s_barrier
    ds_read_b128 v[76:79], v2 offset:0
    ds_read_b128 v[80:83], v2 offset:1024
    ds_read_b128 v[84:87], v2 offset:2048
    s_waitcnt lgkmcnt(0)
    v_add_f32 v52, v52, v84
    v_mov_b32 v145, v52
    v_add_f32 v44, v44, v76
    v_add_f32 v45, v45, v77
    v_permlane32_swap_b32 v52, v145
    v_add_f32 v46, v46, v78
    v_add_f32 v47, v47, v79
    v_add_f32 v48, v48, v80
    v_add_f32 v49, v49, v81
    v_add_f32 v50, v50, v82
    v_add_f32 v51, v51, v83
    v_rcp_f32 v144, v52
    s_nop 0
    v_mul_f32 v44, v44, v144
    v_mul_f32 v45, v45, v144
    v_mul_f32 v46, v46, v144
    v_mul_f32 v47, v47, v144
    v_mul_f32 v48, v48, v144
    v_mul_f32 v49, v49, v144
    v_mul_f32 v50, v50, v144
    v_mul_f32 v51, v51, v144
    v_cvt_pk_bf16_f32 v36, v44, v45
    v_cvt_pk_bf16_f32 v37, v46, v47
    v_cvt_pk_bf16_f32 v38, v48, v49
    v_cvt_pk_bf16_f32 v39, v50, v51
.Lk2_fin1:
    buffer_store_dwordx4 v[36:39], v143, s[16:19], s27 offen sc1
    s_endpgm
.Lk2_barB:
    s_barrier
    s_branch .Lk2_cont
.Lk2_gemm:
    v_mov_b32 v8, v20
    v_mov_b32 v9, v21
    v_mov_b32 v10, v22
    v_mov_b32 v11, v23
    s_sub_u32 s32, s24, 8
    s_lshl_b32 s38, s32, 12
    s_add_u32 s38, s38, 137216
    s_lshl_b32 s27, s32, 2
    s_add_u32 s27, s27, 153600
    v_mov_b32 v27, s27
    v_mov_b32 v1, 0
    ds_write_b32 v27, v1
    ds_write_b32 v27, v1 offset:16
    s_lshr_b32 s27, s32, 1
    s_lshl_b32 s28, s33, 1
    s_add_u32 s29, s28, s27
    s_xor_b32 s30, s29, 1
    s_mul_i32 s27, s32, 28
    s_mul_i32 s35, s29, 112
    s_add_u32 s35, s35, s27
    s_lshl_b32 s35, s35, 10
    s_add_u32 s35, s35, 6291456
    s_mul_i32 s36, s30, 112
    s_add_u32 s36, s36, s27
    s_lshl_b32 s36, s36, 10
    s_add_u32 s36, s36, 6291456
    s_mul_i32 s37, s32, 458752
    s_lshl_b32 s27, s34, 7
    s_add_u32 s37, s37, s27
    v_lshrrev_b32 v4, 3, v3
    v_and_b32 v5, 7, v3
    v_bfe_u32 v6, v4, 1, 1
    v_lshlrev_b32 v6, 2, v6
    v_xor_b32 v6, v5, v6
    v_lshlrev_b32 v6, 4, v6
    v_lshl_add_u32 v24, v4, 10, v6
    v_lshlrev_b32 v1, 9, v8
    v_lshl_add_u32 v1, v10, 7, v1
    v_lshl_add_u32 v1, v11, 3, v1
    v_add_u32 v1, s38, v1
    v_and_b32 v2, 2, v10
    v_xor_b32 v2, v2, v9
    s_and_b32 s27, s32, 1
    s_lshl_b32 s27, s27, 1
    v_xor_b32 v2, s27, v2
    v_lshl_add_u32 v25, v2, 5, v1
    v_xor_b32 v2, 2, v2
    v_lshl_add_u32 v26, v2, 5, v1
    v_mov_b32 v32, 0
    v_mov_b32 v33, 0
    v_mov_b32 v34, 0
    v_mov_b32 v35, 0
    v_mov_b32 v36, 0
    v_mov_b32 v37, 0
    v_mov_b32 v38, 0
    v_mov_b32 v39, 0
    v_mov_b32 v40, 0
    v_mov_b32 v41, 0
    v_mov_b32 v42, 0
    v_mov_b32 v43, 0
    v_mov_b32 v44, 0
    v_mov_b32 v45, 0
    v_mov_b32 v46, 0
    v_mov_b32 v47, 0
    v_mov_b32 v48, 0
    v_mov_b32 v49, 0
    v_mov_b32 v50, 0
    v_mov_b32 v51, 0
    v_mov_b32 v52, 0
    v_mov_b32 v53, 0
    v_mov_b32 v54, 0
    v_mov_b32 v55, 0
    v_mov_b32 v56, 0
    v_mov_b32 v57, 0
    v_mov_b32 v58, 0
    v_mov_b32 v59, 0
    v_mov_b32 v60, 0
    v_mov_b32 v61, 0
    v_mov_b32 v62, 0
    v_mov_b32 v63, 0
    v_mov_b32 v64, 0
    v_mov_b32 v65, 0
    v_mov_b32 v66, 0
    v_mov_b32 v67, 0
    v_mov_b32 v68, 0
    v_mov_b32 v69, 0
    v_mov_b32 v70, 0
    v_mov_b32 v71, 0
    v_mov_b32 v72, 0
    v_mov_b32 v73, 0
    v_mov_b32 v74, 0
    v_mov_b32 v75, 0
    v_mov_b32 v76, 0
    v_mov_b32 v77, 0
    v_mov_b32 v78, 0
    v_mov_b32 v79, 0
    v_mov_b32 v80, 0
    v_mov_b32 v81, 0
    v_mov_b32 v82, 0
    v_mov_b32 v83, 0
    v_mov_b32 v84, 0
    v_mov_b32 v85, 0
    v_mov_b32 v86, 0
    v_mov_b32 v87, 0
    v_mov_b32 v88, 0
    v_mov_b32 v89, 0
    v_mov_b32 v90, 0
    v_mov_b32 v91, 0
    v_mov_b32 v92, 0
    v_mov_b32 v93, 0
    v_mov_b32 v94, 0
    v_mov_b32 v95, 0
    s_waitcnt lgkmcnt(0)
    s_barrier
    s_add_u32 m0, s38, 0
    s_add_u32 s27, s37, 8192
    buffer_load_dwordx4 v24, s[20:23], s37 offen lds
    s_add_u32 m0, s38, 1024
    s_add_u32 s37, s37, 16384
    buffer_load_dwordx4 v24, s[20:23], s27 offen lds
    buffer_load_dwordx4 v[96:99], v143, s[16:19], s35 offen
    buffer_load_dwordx4 v[100:103], v143, s[16:19], s36 offen
    s_add_u32 s35, s35, 1024
    s_add_u32 s36, s36, 1024
    s_add_u32 m0, s38, 2048
    s_add_u32 s27, s37, 8192
    buffer_load_dwordx4 v24, s[20:23], s37 offen lds
    s_add_u32 m0, s38, 3072
    s_add_u32 s37, s37, 16384
    buffer_load_dwordx4 v24, s[20:23], s27 offen lds
    buffer_load_dwordx4 v[104:107], v143, s[16:19], s35 offen
    buffer_load_dwordx4 v[108:111], v143, s[16:19], s36 offen
    s_add_u32 s35, s35, 1024
    s_add_u32 s36, s36, 1024
    s_lshr_b32 s27, s32, 1
    s_lshl_b32 s27, s27, 15
    s_add_u32 s27, s27, 10240
    s_and_b32 s28, s32, 1
    s_lshl_b32 s29, s28, 16
    s_add_u32 s29, s29, s27
    s_lshl_b32 s28, s28, 21
    s_add_u32 s28, s28, s27
    s_lshl_b32 s27, s25, 16
    s_add_u32 s28, s28, s27
    s_add_u32 s28, s28, 2097152
    s_add_u32 m0, s29, 0
    s_add_u32 s46, s28, 0
    buffer_load_dwordx4 v143, s[16:19], s46 offen offset:0 lds
    buffer_load_dwordx4 v143, s[16:19], s46 offen offset:1024 lds
    buffer_load_dwordx4 v143, s[16:19], s46 offen offset:2048 lds
    buffer_load_dwordx4 v143, s[16:19], s46 offen offset:3072 lds
    s_add_u32 m0, s29, 4096
    s_add_u32 s46, s28, 4096
    buffer_load_dwordx4 v143, s[16:19], s46 offen offset:0 lds
    buffer_load_dwordx4 v143, s[16:19], s46 offen offset:1024 lds
    buffer_load_dwordx4 v143, s[16:19], s46 offen offset:2048 lds
    buffer_load_dwordx4 v143, s[16:19], s46 offen offset:3072 lds
    s_add_u32 m0, s29, 8192
    s_add_u32 s46, s28, 8192
    buffer_load_dwordx4 v143, s[16:19], s46 offen offset:0 lds
    buffer_load_dwordx4 v143, s[16:19], s46 offen offset:1024 lds
    buffer_load_dwordx4 v143, s[16:19], s46 offen offset:2048 lds
    buffer_load_dwordx4 v143, s[16:19], s46 offen offset:3072 lds
    s_add_u32 m0, s29, 12288
    s_add_u32 s46, s28, 12288
    buffer_load_dwordx4 v143, s[16:19], s46 offen offset:0 lds
    buffer_load_dwordx4 v143, s[16:19], s46 offen offset:1024 lds
    buffer_load_dwordx4 v143, s[16:19], s46 offen offset:2048 lds
    buffer_load_dwordx4 v143, s[16:19], s46 offen offset:3072 lds
    s_add_u32 m0, s29, 16384
    s_add_u32 s46, s28, 16384
    buffer_load_dwordx4 v143, s[16:19], s46 offen offset:0 lds
    buffer_load_dwordx4 v143, s[16:19], s46 offen offset:1024 lds
    buffer_load_dwordx4 v143, s[16:19], s46 offen offset:2048 lds
    buffer_load_dwordx4 v143, s[16:19], s46 offen offset:3072 lds
    s_add_u32 m0, s29, 20480
    s_add_u32 s46, s28, 20480
    buffer_load_dwordx4 v143, s[16:19], s46 offen offset:0 lds
    buffer_load_dwordx4 v143, s[16:19], s46 offen offset:1024 lds
    s_mov_b32 s31, 0
.Lk2_gloop:
    s_waitcnt vmcnt(4)
    ds_read_b64_tr_b16 v[8:9], v25 offset:0
    ds_read_b64_tr_b16 v[10:11], v25 offset:1024
    ds_read_b64_tr_b16 v[12:13], v26 offset:0
    ds_read_b64_tr_b16 v[14:15], v26 offset:1024
    s_waitcnt lgkmcnt(0)
    v_mfma_f32_32x32x16_bf16 v[32:47], v[8:11], v[96:99], v[32:47]
    v_mfma_f32_32x32x16_bf16 v[48:63], v[12:15], v[96:99], v[48:63]
    v_mfma_f32_32x32x16_bf16 v[64:79], v[8:11], v[100:103], v[64:79]
    v_mfma_f32_32x32x16_bf16 v[80:95], v[12:15], v[100:103], v[80:95]
    s_add_u32 m0, s38, 0
    s_add_u32 s27, s37, 8192
    buffer_load_dwordx4 v24, s[20:23], s37 offen lds
    s_add_u32 m0, s38, 1024
    s_add_u32 s37, s37, 16384
    buffer_load_dwordx4 v24, s[20:23], s27 offen lds
    buffer_load_dwordx4 v[96:99], v143, s[16:19], s35 offen
    buffer_load_dwordx4 v[100:103], v143, s[16:19], s36 offen
    s_add_u32 s35, s35, 1024
    s_add_u32 s36, s36, 1024
    s_waitcnt vmcnt(4)
    ds_read_b64_tr_b16 v[8:9], v25 offset:2048
    ds_read_b64_tr_b16 v[10:11], v25 offset:3072
    ds_read_b64_tr_b16 v[12:13], v26 offset:2048
    ds_read_b64_tr_b16 v[14:15], v26 offset:3072
    s_waitcnt lgkmcnt(0)
    v_mfma_f32_32x32x16_bf16 v[32:47], v[8:11], v[104:107], v[32:47]
    v_mfma_f32_32x32x16_bf16 v[48:63], v[12:15], v[104:107], v[48:63]
    v_mfma_f32_32x32x16_bf16 v[64:79], v[8:11], v[108:111], v[64:79]
    v_mfma_f32_32x32x16_bf16 v[80:95], v[12:15], v[108:111], v[80:95]
    s_add_u32 m0, s38, 2048
    s_add_u32 s27, s37, 8192
    buffer_load_dwordx4 v24, s[20:23], s37 offen lds
    s_add_u32 m0, s38, 3072
    s_add_u32 s37, s37, 16384
    buffer_load_dwordx4 v24, s[20:23], s27 offen lds
    buffer_load_dwordx4 v[104:107], v143, s[16:19], s35 offen
    buffer_load_dwordx4 v[108:111], v143, s[16:19], s36 offen
    s_add_u32 s35, s35, 1024
    s_add_u32 s36, s36, 1024
    s_add_u32 s31, s31, 1
    s_cmp_eq_u32 s31, 2
    s_cbranch_scc0 .Lk2_gnob
    s_barrier
.Lk2_gnob:
    s_cmp_lt_u32 s31, 12
    s_cbranch_scc1 .Lk2_gloop
    v_mov_b32 v31, v143
    s_mov_b32 s48, s8
    s_mov_b32 s49, s9
    s_mov_b32 s50, 524288
    s_mov_b32 s51, 131072
    s_mov_b32 s52, s10
    s_mov_b32 s53, s11
    s_mov_b32 s54, 2097152
    s_mov_b32 s55, 131072
    s_mov_b32 s56, s12
    s_mov_b32 s57, s13
    s_mov_b32 s58, 2097152
    s_mov_b32 s59, 131072
    s_lshr_b32 s27, s32, 1
    s_lshl_b32 s28, s33, 1
    s_add_u32 s29, s28, s27
    s_xor_b32 s30, s29, 1
    s_lshl_b32 s62, s29, 15
    s_lshl_b32 s27, s34, 7
    s_add_u32 s62, s62, s27
    s_and_b32 s28, s32, 1
    s_lshl_b32 s28, s28, 6
    s_add_u32 s62, s62, s28
    v_and_b32 v6, 31, v3
    v_lshrrev_b32 v7, 5, v3
    v_lshlrev_b32 v6, 10, v6
    v_lshl_add_u32 v29, v7, 4, v6
    buffer_load_dwordx4 v[160:163], v29, s[52:55], s62 offen
    buffer_load_dwordx4 v[164:167], v29, s[52:55], s62 offen offset:32
    s_lshl_b32 s65, s32, 17
    s_add_u32 s65, s65, s27
    v_lshlrev_b32 v1, 10, v3
    buffer_load_dword v128, v1, s[48:51], s65 offen
    s_add_u32 s65, s65, 65536
    buffer_load_dword v129, v1, s[48:51], s65 offen
    s_lshl_b32 s28, s32, 3
    s_lshl_b32 s66, s29, 5
    s_add_u32 s66, s66, s28
    s_lshl_b32 s66, s66, 10
    s_add_u32 s66, s66, 14680064
    s_lshl_b32 s67, s30, 5
    s_add_u32 s67, s67, s28
    s_lshl_b32 s67, s67, 10
    s_add_u32 s67, s67, 14680064
    s_lshl_b32 s68, s32, 17
    s_add_u32 s68, s68, s27
    s_lshl_b32 s63, s32, 14
    s_add_u32 s63, s63, 65536
    v_lshrrev_b32 v8, 5, v3
    v_bfe_u32 v9, v3, 4, 1
    v_bfe_u32 v10, v3, 2, 2
    v_and_b32 v11, 3, v3
    v_lshlrev_b32 v1, 10, v8
    v_lshl_add_u32 v1, v10, 7, v1
    v_lshl_add_u32 v1, v11, 3, v1
    v_add_u32 v1, s63, v1
    v_and_b32 v2, 2, v10
    v_xor_b32 v2, v2, v9
    s_and_b32 s27, s32, 1
    s_lshl_b32 s27, s27, 1
    v_xor_b32 v2, s27, v2
    v_lshl_add_u32 v27, v2, 5, v1
    v_xor_b32 v2, 2, v2
    v_lshl_add_u32 v28, v2, 5, v1
    s_lshl_b32 s64, s33, 2
    s_add_u32 s64, s64, s32
    s_lshl_b32 s64, s64, 7
    s_add_u32 s64, s64, 19922944
    v_mov_b32 v30, 0
    s_waitcnt vmcnt(2)
    v_lshlrev_b32 v112, 16, v160
    v_and_b32 v113, 0xffff0000, v160
    v_lshlrev_b32 v114, 16, v161
    v_and_b32 v115, 0xffff0000, v161
    v_lshlrev_b32 v116, 16, v162
    v_and_b32 v117, 0xffff0000, v162
    v_lshlrev_b32 v118, 16, v163
    v_and_b32 v119, 0xffff0000, v163
    v_lshlrev_b32 v120, 16, v164
    v_and_b32 v121, 0xffff0000, v164
    v_lshlrev_b32 v122, 16, v165
    v_and_b32 v123, 0xffff0000, v165
    v_lshlrev_b32 v124, 16, v166
    v_and_b32 v125, 0xffff0000, v166
    v_lshlrev_b32 v126, 16, v167
    v_and_b32 v127, 0xffff0000, v167
    v_permlane32_swap_b32 v112, v116
    v_permlane32_swap_b32 v113, v117
    v_permlane32_swap_b32 v114, v118
    v_permlane32_swap_b32 v115, v119
    v_permlane32_swap_b32 v120, v124
    v_permlane32_swap_b32 v121, v125
    v_permlane32_swap_b32 v122, v126
    v_permlane32_swap_b32 v123, v127
    v_add_f32 v32, v32, v112
    v_add_f32 v33, v33, v113
    v_add_f32 v34, v34, v114
    v_add_f32 v35, v35, v115
    v_add_f32 v36, v36, v116
    v_add_f32 v37, v37, v117
    v_add_f32 v38, v38, v118
    v_add_f32 v39, v39, v119
    v_add_f32 v40, v40, v120
    v_add_f32 v41, v41, v121
    v_add_f32 v42, v42, v122
    v_add_f32 v43, v43, v123
    v_add_f32 v44, v44, v124
    v_add_f32 v45, v45, v125
    v_add_f32 v46, v46, v126
    v_add_f32 v47, v47, v127
    s_barrier
    s_barrier
    s_waitcnt vmcnt(4)
    ds_read_b64_tr_b16 v[8:9], v25 offset:0
    ds_read_b64_tr_b16 v[10:11], v25 offset:1024
    ds_read_b64_tr_b16 v[12:13], v26 offset:0
    ds_read_b64_tr_b16 v[14:15], v26 offset:1024
    s_waitcnt lgkmcnt(0)
    v_mfma_f32_32x32x16_bf16 v[32:47], v[8:11], v[96:99], v[32:47]
    v_mfma_f32_32x32x16_bf16 v[48:63], v[12:15], v[96:99], v[48:63]
    v_mfma_f32_32x32x16_bf16 v[64:79], v[8:11], v[100:103], v[64:79]
    v_mfma_f32_32x32x16_bf16 v[80:95], v[12:15], v[100:103], v[80:95]
    s_add_u32 m0, s38, 0
    s_add_u32 s27, s37, 8192
    buffer_load_dwordx4 v24, s[20:23], s37 offen lds
    s_add_u32 m0, s38, 1024
    s_add_u32 s37, s37, 16384
    buffer_load_dwordx4 v24, s[20:23], s27 offen lds
    buffer_load_dwordx4 v[96:99], v143, s[16:19], s35 offen
    buffer_load_dwordx4 v[100:103], v143, s[16:19], s36 offen
    s_add_u32 s35, s35, 1024
    s_add_u32 s36, s36, 1024
    s_waitcnt vmcnt(4)
    ds_read_b64_tr_b16 v[8:9], v25 offset:2048
    ds_read_b64_tr_b16 v[10:11], v25 offset:3072
    ds_read_b64_tr_b16 v[12:13], v26 offset:2048
    ds_read_b64_tr_b16 v[14:15], v26 offset:3072
    s_waitcnt lgkmcnt(0)
    v_mfma_f32_32x32x16_bf16 v[32:47], v[8:11], v[104:107], v[32:47]
    v_mfma_f32_32x32x16_bf16 v[48:63], v[12:15], v[104:107], v[48:63]
    v_mfma_f32_32x32x16_bf16 v[64:79], v[8:11], v[108:111], v[64:79]
    v_mfma_f32_32x32x16_bf16 v[80:95], v[12:15], v[108:111], v[80:95]
    s_add_u32 m0, s38, 2048
    s_add_u32 s27, s37, 8192
    buffer_load_dwordx4 v24, s[20:23], s37 offen lds
    s_add_u32 m0, s38, 3072
    s_add_u32 s37, s37, 16384
    buffer_load_dwordx4 v24, s[20:23], s27 offen lds
    buffer_load_dwordx4 v[104:107], v143, s[16:19], s35 offen
    buffer_load_dwordx4 v[108:111], v143, s[16:19], s36 offen
    s_add_u32 s35, s35, 1024
    s_add_u32 s36, s36, 1024
    s_waitcnt vmcnt(4)
    ds_read_b64_tr_b16 v[8:9], v25 offset:0
    ds_read_b64_tr_b16 v[10:11], v25 offset:1024
    ds_read_b64_tr_b16 v[12:13], v26 offset:0
    ds_read_b64_tr_b16 v[14:15], v26 offset:1024
    s_waitcnt lgkmcnt(0)
    v_mfma_f32_32x32x16_bf16 v[32:47], v[8:11], v[96:99], v[32:47]
    v_mfma_f32_32x32x16_bf16 v[48:63], v[12:15], v[96:99], v[48:63]
    v_mfma_f32_32x32x16_bf16 v[64:79], v[8:11], v[100:103], v[64:79]
    v_mfma_f32_32x32x16_bf16 v[80:95], v[12:15], v[100:103], v[80:95]
    s_waitcnt vmcnt(0)
    ds_read_b64_tr_b16 v[8:9], v25 offset:2048
    ds_read_b64_tr_b16 v[10:11], v25 offset:3072
    ds_read_b64_tr_b16 v[12:13], v26 offset:2048
    ds_read_b64_tr_b16 v[14:15], v26 offset:3072
    s_waitcnt lgkmcnt(0)
    v_mfma_f32_32x32x16_bf16 v[32:47], v[8:11], v[104:107], v[32:47]
    v_mfma_f32_32x32x16_bf16 v[48:63], v[12:15], v[104:107], v[48:63]
    v_mfma_f32_32x32x16_bf16 v[64:79], v[8:11], v[108:111], v[64:79]
    v_mfma_f32_32x32x16_bf16 v[80:95], v[12:15], v[108:111], v[80:95]
    s_add_u32 m0, s63, 0
    s_add_u32 s27, s68, 0
    buffer_load_dwordx4 v24, s[48:51], s27 offen lds
    s_add_u32 m0, s63, 1024
    s_add_u32 s27, s68, 8192
    buffer_load_dwordx4 v24, s[48:51], s27 offen lds
    s_add_u32 m0, s63, 2048
    s_add_u32 s27, s68, 16384
    buffer_load_dwordx4 v24, s[48:51], s27 offen lds
    s_add_u32 m0, s63, 3072
    s_add_u32 s27, s68, 24576
    buffer_load_dwordx4 v24, s[48:51], s27 offen lds
    s_add_u32 m0, s63, 4096
    s_add_u32 s27, s68, 32768
    buffer_load_dwordx4 v24, s[48:51], s27 offen lds
    s_add_u32 m0, s63, 5120
    s_add_u32 s27, s68, 40960
    buffer_load_dwordx4 v24, s[48:51], s27 offen lds
    s_add_u32 m0, s63, 6144
    s_add_u32 s27, s68, 49152
    buffer_load_dwordx4 v24, s[48:51], s27 offen lds
    s_add_u32 m0, s63, 7168
    s_add_u32 s27, s68, 57344
    buffer_load_dwordx4 v24, s[48:51], s27 offen lds
    s_add_u32 m0, s63, 8192
    s_add_u32 s27, s68, 65536
    buffer_load_dwordx4 v24, s[48:51], s27 offen lds
    s_add_u32 m0, s63, 9216
    s_add_u32 s27, s68, 73728
    buffer_load_dwordx4 v24, s[48:51], s27 offen lds
    s_add_u32 m0, s63, 10240
    s_add_u32 s27, s68, 81920
    buffer_load_dwordx4 v24, s[48:51], s27 offen lds
    s_add_u32 m0, s63, 11264
    s_add_u32 s27, s68, 90112
    buffer_load_dwordx4 v24, s[48:51], s27 offen lds
    s_add_u32 m0, s63, 12288
    s_add_u32 s27, s68, 98304
    buffer_load_dwordx4 v24, s[48:51], s27 offen lds
    s_add_u32 m0, s63, 13312
    s_add_u32 s27, s68, 106496
    buffer_load_dwordx4 v24, s[48:51], s27 offen lds
    s_add_u32 m0, s63, 14336
    s_add_u32 s27, s68, 114688
    buffer_load_dwordx4 v24, s[48:51], s27 offen lds
    s_add_u32 m0, s63, 15360
    s_add_u32 s27, s68, 122880
    buffer_load_dwordx4 v24, s[48:51], s27 offen lds
    s_add_u32 s69, s66, 4096
    s_add_u32 s70, s67, 4096
    s_waitcnt vmcnt(0)
    s_mov_b32 s31, 0
    buffer_load_dwordx4 v[96:99], v31, s[16:19], s66 offen offset:0 sc1
    buffer_load_dwordx4 v[100:103], v31, s[16:19], s67 offen offset:0 sc1
    buffer_load_dwordx4 v[104:107], v31, s[16:19], s66 offen offset:1024 sc1
    buffer_load_dwordx4 v[108:111], v31, s[16:19], s67 offen offset:1024 sc1
    buffer_load_dwordx4 v[112:115], v31, s[16:19], s66 offen offset:2048 sc1
    buffer_load_dwordx4 v[116:119], v31, s[16:19], s67 offen offset:2048 sc1
    buffer_load_dwordx4 v[120:123], v31, s[16:19], s66 offen offset:3072 sc1
    buffer_load_dwordx4 v[124:127], v31, s[16:19], s67 offen offset:3072 sc1
    buffer_load_dwordx4 v[128:131], v31, s[16:19], s69 offen offset:0 sc1
    buffer_load_dwordx4 v[132:135], v31, s[16:19], s70 offen offset:0 sc1
    buffer_load_dwordx4 v[136:139], v31, s[16:19], s69 offen offset:1024 sc1
    buffer_load_dwordx4 v[140:143], v31, s[16:19], s70 offen offset:1024 sc1
    buffer_load_dwordx4 v[144:147], v31, s[16:19], s69 offen offset:2048 sc1
    buffer_load_dwordx4 v[148:151], v31, s[16:19], s70 offen offset:2048 sc1
    buffer_load_dwordx4 v[152:155], v31, s[16:19], s69 offen offset:3072 sc1
    buffer_load_dwordx4 v[156:159], v31, s[16:19], s70 offen offset:3072 sc1
    ds_read_b64_tr_b16 v[8:9], v27 offset:0
    ds_read_b64_tr_b16 v[10:11], v27 offset:512
    ds_read_b64_tr_b16 v[12:13], v28 offset:0
    ds_read_b64_tr_b16 v[14:15], v28 offset:512
    ds_read_b64_tr_b16 v[16:17], v27 offset:2048
    ds_read_b64_tr_b16 v[18:19], v27 offset:2560
    ds_read_b64_tr_b16 v[20:21], v28 offset:2048
    ds_read_b64_tr_b16 v[22:23], v28 offset:2560
    s_waitcnt vmcnt(14) lgkmcnt(4)
.Lk2_ochk0:
    v_max3_u32 v2, v96, v97, v98
    v_max3_u32 v4, v99, v100, v101
    v_max3_u32 v2, v2, v102, v103
    v_max_u32 v2, v2, v4
    v_cmp_eq_u32 vcc, -1, v2
    s_nop 4
    s_cbranch_vccnz .Lk2_oretry0
.Lk2_ook0:
    v_mfma_f32_32x32x16_bf16 v[48:63], v[12:15], v[96:99], v[48:63]
    v_mfma_f32_32x32x16_bf16 v[64:79], v[8:11], v[100:103], v[64:79]
    v_mfma_f32_32x32x16_bf16 v[80:95], v[12:15], v[100:103], v[80:95]
    v_mfma_f32_32x32x16_bf16 v[32:47], v[8:11], v[96:99], v[32:47]
    ds_read_b64_tr_b16 v[8:9], v27 offset:4096
    ds_read_b64_tr_b16 v[10:11], v27 offset:4608
    ds_read_b64_tr_b16 v[12:13], v28 offset:4096
    ds_read_b64_tr_b16 v[14:15], v28 offset:4608
    s_waitcnt vmcnt(12) lgkmcnt(4)
.Lk2_ochk1:
    v_max3_u32 v2, v104, v105, v106
    v_max3_u32 v4, v107, v108, v109
    v_max3_u32 v2, v2, v110, v111
    v_max_u32 v2, v2, v4
    v_cmp_eq_u32 vcc, -1, v2
    s_nop 4
    s_cbranch_vccnz .Lk2_oretry1
.Lk2_ook1:
    v_mfma_f32_32x32x16_bf16 v[48:63], v[20:23], v[104:107], v[48:63]
    v_mfma_f32_32x32x16_bf16 v[64:79], v[16:19], v[108:111], v[64:79]
    v_mfma_f32_32x32x16_bf16 v[80:95], v[20:23], v[108:111], v[80:95]
    v_mfma_f32_32x32x16_bf16 v[32:47], v[16:19], v[104:107], v[32:47]
    ds_read_b64_tr_b16 v[16:17], v27 offset:6144
    ds_read_b64_tr_b16 v[18:19], v27 offset:6656
    ds_read_b64_tr_b16 v[20:21], v28 offset:6144
    ds_read_b64_tr_b16 v[22:23], v28 offset:6656
    s_waitcnt vmcnt(10) lgkmcnt(4)
.Lk2_ochk2:
    v_max3_u32 v2, v112, v113, v114
    v_max3_u32 v4, v115, v116, v117
    v_max3_u32 v2, v2, v118, v119
    v_max_u32 v2, v2, v4
    v_cmp_eq_u32 vcc, -1, v2
    s_nop 4
    s_cbranch_vccnz .Lk2_oretry2
.Lk2_ook2:
    v_mfma_f32_32x32x16_bf16 v[48:63], v[12:15], v[112:115], v[48:63]
    v_mfma_f32_32x32x16_bf16 v[64:79], v[8:11], v[116:119], v[64:79]
    v_mfma_f32_32x32x16_bf16 v[80:95], v[12:15], v[116:119], v[80:95]
    v_mfma_f32_32x32x16_bf16 v[32:47], v[8:11], v[112:115], v[32:47]
    ds_read_b64_tr_b16 v[8:9], v27 offset:8192
    ds_read_b64_tr_b16 v[10:11], v27 offset:8704
    ds_read_b64_tr_b16 v[12:13], v28 offset:8192
    ds_read_b64_tr_b16 v[14:15], v28 offset:8704
    s_waitcnt vmcnt(8) lgkmcnt(4)
.Lk2_ochk3:
    v_max3_u32 v2, v120, v121, v122
    v_max3_u32 v4, v123, v124, v125
    v_max3_u32 v2, v2, v126, v127
    v_max_u32 v2, v2, v4
    v_cmp_eq_u32 vcc, -1, v2
    s_nop 4
    s_cbranch_vccnz .Lk2_oretry3
.Lk2_ook3:
    v_mfma_f32_32x32x16_bf16 v[48:63], v[20:23], v[120:123], v[48:63]
    v_mfma_f32_32x32x16_bf16 v[64:79], v[16:19], v[124:127], v[64:79]
    v_mfma_f32_32x32x16_bf16 v[80:95], v[20:23], v[124:127], v[80:95]
    v_mfma_f32_32x32x16_bf16 v[32:47], v[16:19], v[120:123], v[32:47]
    ds_read_b64_tr_b16 v[16:17], v27 offset:10240
    ds_read_b64_tr_b16 v[18:19], v27 offset:10752
    ds_read_b64_tr_b16 v[20:21], v28 offset:10240
    ds_read_b64_tr_b16 v[22:23], v28 offset:10752
    s_waitcnt vmcnt(6) lgkmcnt(4)
.Lk2_ochk4:
    v_max3_u32 v2, v128, v129, v130
    v_max3_u32 v4, v131, v132, v133
    v_max3_u32 v2, v2, v134, v135
    v_max_u32 v2, v2, v4
    v_cmp_eq_u32 vcc, -1, v2
    s_nop 4
    s_cbranch_vccnz .Lk2_oretry4
.Lk2_ook4:
    v_mfma_f32_32x32x16_bf16 v[48:63], v[12:15], v[128:131], v[48:63]
    v_mfma_f32_32x32x16_bf16 v[64:79], v[8:11], v[132:135], v[64:79]
    v_mfma_f32_32x32x16_bf16 v[80:95], v[12:15], v[132:135], v[80:95]
    v_mfma_f32_32x32x16_bf16 v[32:47], v[8:11], v[128:131], v[32:47]
    ds_read_b64_tr_b16 v[8:9], v27 offset:12288
    ds_read_b64_tr_b16 v[10:11], v27 offset:12800
    ds_read_b64_tr_b16 v[12:13], v28 offset:12288
    ds_read_b64_tr_b16 v[14:15], v28 offset:12800
    s_waitcnt vmcnt(4) lgkmcnt(4)
.Lk2_ochk5:
    v_max3_u32 v2, v136, v137, v138
    v_max3_u32 v4, v139, v140, v141
    v_max3_u32 v2, v2, v142, v143
    v_max_u32 v2, v2, v4
    v_cmp_eq_u32 vcc, -1, v2
    s_nop 4
    s_cbranch_vccnz .Lk2_oretry5
.Lk2_ook5:
    v_mfma_f32_32x32x16_bf16 v[48:63], v[20:23], v[136:139], v[48:63]
    v_mfma_f32_32x32x16_bf16 v[64:79], v[16:19], v[140:143], v[64:79]
    v_mfma_f32_32x32x16_bf16 v[80:95], v[20:23], v[140:143], v[80:95]
    v_mfma_f32_32x32x16_bf16 v[32:47], v[16:19], v[136:139], v[32:47]
    ds_read_b64_tr_b16 v[16:17], v27 offset:14336
    ds_read_b64_tr_b16 v[18:19], v27 offset:14848
    ds_read_b64_tr_b16 v[20:21], v28 offset:14336
    ds_read_b64_tr_b16 v[22:23], v28 offset:14848
    s_waitcnt vmcnt(2) lgkmcnt(4)
.Lk2_ochk6:
    v_max3_u32 v2, v144, v145, v146
    v_max3_u32 v4, v147, v148, v149
    v_max3_u32 v2, v2, v150, v151
    v_max_u32 v2, v2, v4
    v_cmp_eq_u32 vcc, -1, v2
    s_nop 4
    s_cbranch_vccnz .Lk2_oretry6
.Lk2_ook6:
    v_mfma_f32_32x32x16_bf16 v[48:63], v[12:15], v[144:147], v[48:63]
    v_mfma_f32_32x32x16_bf16 v[64:79], v[8:11], v[148:151], v[64:79]
    v_mfma_f32_32x32x16_bf16 v[80:95], v[12:15], v[148:151], v[80:95]
    v_mfma_f32_32x32x16_bf16 v[32:47], v[8:11], v[144:147], v[32:47]
    s_waitcnt vmcnt(0) lgkmcnt(0)
.Lk2_ochk7:
    v_max3_u32 v2, v152, v153, v154
    v_max3_u32 v4, v155, v156, v157
    v_max3_u32 v2, v2, v158, v159
    v_max_u32 v2, v2, v4
    v_cmp_eq_u32 vcc, -1, v2
    s_nop 4
    s_cbranch_vccnz .Lk2_oretry7
.Lk2_ook7:
    v_mfma_f32_32x32x16_bf16 v[48:63], v[20:23], v[152:155], v[48:63]
    v_mfma_f32_32x32x16_bf16 v[64:79], v[16:19], v[156:159], v[64:79]
    v_mfma_f32_32x32x16_bf16 v[80:95], v[20:23], v[156:159], v[80:95]
    v_mfma_f32_32x32x16_bf16 v[32:47], v[16:19], v[152:155], v[32:47]
    s_mul_i32 s27, s32, 12288
    v_add_u32 v1, s27, v31
    s_nop 6
    ds_write_b128 v1, v[48:51] offset:0
    ds_write_b128 v1, v[52:55] offset:1024
    ds_write_b128 v1, v[56:59] offset:2048
    ds_write_b128 v1, v[60:63] offset:3072
    ds_write_b128 v1, v[64:67] offset:4096
    ds_write_b128 v1, v[68:71] offset:5120
    ds_write_b128 v1, v[72:75] offset:6144
    ds_write_b128 v1, v[76:79] offset:7168
    ds_write_b128 v1, v[80:83] offset:8192
    ds_write_b128 v1, v[84:87] offset:9216
    ds_write_b128 v1, v[88:91] offset:10240
    ds_write_b128 v1, v[92:95] offset:11264
    s_xor_b32 s27, s32, 1
    s_mul_i32 s27, s27, 12288
    s_add_u32 s27, s27, 0
    v_add_u32 v5, s27, v31
    s_xor_b32 s27, s32, 2
    s_mul_i32 s27, s27, 12288
    s_add_u32 s27, s27, 4096
    v_add_u32 v6, s27, v31
    s_xor_b32 s27, s32, 3
    s_mul_i32 s27, s27, 12288
    s_add_u32 s27, s27, 8192
    v_add_u32 v7, s27, v31
    s_waitcnt lgkmcnt(0)
    s_barrier
    ds_read_b128 v[96:99], v5 offset:0
    ds_read_b128 v[100:103], v5 offset:1024
    ds_read_b128 v[104:107], v5 offset:2048
    ds_read_b128 v[108:111], v5 offset:3072
    ds_read_b128 v[112:115], v6 offset:0
    ds_read_b128 v[116:119], v6 offset:1024
    ds_read_b128 v[120:123], v6 offset:2048
    ds_read_b128 v[124:127], v6 offset:3072
    ds_read_b128 v[128:131], v7 offset:0
    ds_read_b128 v[132:135], v7 offset:1024
    ds_read_b128 v[136:139], v7 offset:2048
    ds_read_b128 v[140:143], v7 offset:3072
    s_waitcnt lgkmcnt(8)
    v_pk_add_f32 v[32:33], v[32:33], v[96:97]
    v_pk_add_f32 v[34:35], v[34:35], v[98:99]
    v_pk_add_f32 v[36:37], v[36:37], v[100:101]
    v_pk_add_f32 v[38:39], v[38:39], v[102:103]
    v_pk_add_f32 v[40:41], v[40:41], v[104:105]
    v_pk_add_f32 v[42:43], v[42:43], v[106:107]
    v_pk_add_f32 v[44:45], v[44:45], v[108:109]
    v_pk_add_f32 v[46:47], v[46:47], v[110:111]
    s_waitcnt lgkmcnt(4)
    v_pk_add_f32 v[32:33], v[32:33], v[112:113]
    v_pk_add_f32 v[34:35], v[34:35], v[114:115]
    v_pk_add_f32 v[36:37], v[36:37], v[116:117]
    v_pk_add_f32 v[38:39], v[38:39], v[118:119]
    v_pk_add_f32 v[40:41], v[40:41], v[120:121]
    v_pk_add_f32 v[42:43], v[42:43], v[122:123]
    v_pk_add_f32 v[44:45], v[44:45], v[124:125]
    v_pk_add_f32 v[46:47], v[46:47], v[126:127]
    s_waitcnt lgkmcnt(0)
    v_pk_add_f32 v[32:33], v[32:33], v[128:129]
    v_pk_add_f32 v[34:35], v[34:35], v[130:131]
    v_pk_add_f32 v[36:37], v[36:37], v[132:133]
    v_pk_add_f32 v[38:39], v[38:39], v[134:135]
    v_pk_add_f32 v[40:41], v[40:41], v[136:137]
    v_pk_add_f32 v[42:43], v[42:43], v[138:139]
    v_pk_add_f32 v[44:45], v[44:45], v[140:141]
    v_pk_add_f32 v[46:47], v[46:47], v[142:143]
    v_cvt_pk_bf16_f32 v48, v32, v33
    v_cvt_pk_bf16_f32 v49, v34, v35
    v_cvt_pk_bf16_f32 v50, v36, v37
    v_cvt_pk_bf16_f32 v51, v38, v39
    v_cvt_pk_bf16_f32 v52, v40, v41
    v_cvt_pk_bf16_f32 v53, v42, v43
    v_cvt_pk_bf16_f32 v54, v44, v45
    v_cvt_pk_bf16_f32 v55, v46, v47
    v_permlane32_swap_b32 v48, v50
    v_permlane32_swap_b32 v49, v51
    v_permlane32_swap_b32 v52, v54
    v_permlane32_swap_b32 v53, v55
    buffer_store_dwordx4 v[48:51], v29, s[56:59], s62 offen offset:0 nt
    buffer_store_dwordx4 v[52:55], v29, s[56:59], s62 offen offset:32 nt
.Lk2_end:
    s_endpgm
.Lk2_oretry0:
    s_add_u32 s31, s31, 1
    s_cmp_ge_u32 s31, 262144
    s_cbranch_scc1 .Lk2_ook0
    buffer_load_dwordx4 v[96:99], v31, s[16:19], s66 offen offset:0 sc1
    buffer_load_dwordx4 v[100:103], v31, s[16:19], s67 offen offset:0 sc1
    buffer_load_dwordx4 v[104:107], v31, s[16:19], s66 offen offset:1024 sc1
    buffer_load_dwordx4 v[108:111], v31, s[16:19], s67 offen offset:1024 sc1
    buffer_load_dwordx4 v[112:115], v31, s[16:19], s66 offen offset:2048 sc1
    buffer_load_dwordx4 v[116:119], v31, s[16:19], s67 offen offset:2048 sc1
    buffer_load_dwordx4 v[120:123], v31, s[16:19], s66 offen offset:3072 sc1
    buffer_load_dwordx4 v[124:127], v31, s[16:19], s67 offen offset:3072 sc1
    buffer_load_dwordx4 v[128:131], v31, s[16:19], s69 offen offset:0 sc1
    buffer_load_dwordx4 v[132:135], v31, s[16:19], s70 offen offset:0 sc1
    buffer_load_dwordx4 v[136:139], v31, s[16:19], s69 offen offset:1024 sc1
    buffer_load_dwordx4 v[140:143], v31, s[16:19], s70 offen offset:1024 sc1
    buffer_load_dwordx4 v[144:147], v31, s[16:19], s69 offen offset:2048 sc1
    buffer_load_dwordx4 v[148:151], v31, s[16:19], s70 offen offset:2048 sc1
    buffer_load_dwordx4 v[152:155], v31, s[16:19], s69 offen offset:3072 sc1
    buffer_load_dwordx4 v[156:159], v31, s[16:19], s70 offen offset:3072 sc1
    s_waitcnt vmcnt(0)
    s_branch .Lk2_ochk0
.Lk2_oretry1:
    s_add_u32 s31, s31, 1
    s_cmp_ge_u32 s31, 262144
    s_cbranch_scc1 .Lk2_ook1
    buffer_load_dwordx4 v[104:107], v31, s[16:19], s66 offen offset:1024 sc1
    buffer_load_dwordx4 v[108:111], v31, s[16:19], s67 offen offset:1024 sc1
    buffer_load_dwordx4 v[112:115], v31, s[16:19], s66 offen offset:2048 sc1
    buffer_load_dwordx4 v[116:119], v31, s[16:19], s67 offen offset:2048 sc1
    buffer_load_dwordx4 v[120:123], v31, s[16:19], s66 offen offset:3072 sc1
    buffer_load_dwordx4 v[124:127], v31, s[16:19], s67 offen offset:3072 sc1
    buffer_load_dwordx4 v[128:131], v31, s[16:19], s69 offen offset:0 sc1
    buffer_load_dwordx4 v[132:135], v31, s[16:19], s70 offen offset:0 sc1
    buffer_load_dwordx4 v[136:139], v31, s[16:19], s69 offen offset:1024 sc1
    buffer_load_dwordx4 v[140:143], v31, s[16:19], s70 offen offset:1024 sc1
    buffer_load_dwordx4 v[144:147], v31, s[16:19], s69 offen offset:2048 sc1
    buffer_load_dwordx4 v[148:151], v31, s[16:19], s70 offen offset:2048 sc1
    buffer_load_dwordx4 v[152:155], v31, s[16:19], s69 offen offset:3072 sc1
    buffer_load_dwordx4 v[156:159], v31, s[16:19], s70 offen offset:3072 sc1
    s_waitcnt vmcnt(0)
    s_branch .Lk2_ochk1
.Lk2_oretry2:
    s_add_u32 s31, s31, 1
    s_cmp_ge_u32 s31, 262144
    s_cbranch_scc1 .Lk2_ook2
    buffer_load_dwordx4 v[112:115], v31, s[16:19], s66 offen offset:2048 sc1
    buffer_load_dwordx4 v[116:119], v31, s[16:19], s67 offen offset:2048 sc1
    buffer_load_dwordx4 v[120:123], v31, s[16:19], s66 offen offset:3072 sc1
    buffer_load_dwordx4 v[124:127], v31, s[16:19], s67 offen offset:3072 sc1
    buffer_load_dwordx4 v[128:131], v31, s[16:19], s69 offen offset:0 sc1
    buffer_load_dwordx4 v[132:135], v31, s[16:19], s70 offen offset:0 sc1
    buffer_load_dwordx4 v[136:139], v31, s[16:19], s69 offen offset:1024 sc1
    buffer_load_dwordx4 v[140:143], v31, s[16:19], s70 offen offset:1024 sc1
    buffer_load_dwordx4 v[144:147], v31, s[16:19], s69 offen offset:2048 sc1
    buffer_load_dwordx4 v[148:151], v31, s[16:19], s70 offen offset:2048 sc1
    buffer_load_dwordx4 v[152:155], v31, s[16:19], s69 offen offset:3072 sc1
    buffer_load_dwordx4 v[156:159], v31, s[16:19], s70 offen offset:3072 sc1
    s_waitcnt vmcnt(0)
    s_branch .Lk2_ochk2
.Lk2_oretry3:
    s_add_u32 s31, s31, 1
    s_cmp_ge_u32 s31, 262144
    s_cbranch_scc1 .Lk2_ook3
    buffer_load_dwordx4 v[120:123], v31, s[16:19], s66 offen offset:3072 sc1
    buffer_load_dwordx4 v[124:127], v31, s[16:19], s67 offen offset:3072 sc1
    buffer_load_dwordx4 v[128:131], v31, s[16:19], s69 offen offset:0 sc1
    buffer_load_dwordx4 v[132:135], v31, s[16:19], s70 offen offset:0 sc1
    buffer_load_dwordx4 v[136:139], v31, s[16:19], s69 offen offset:1024 sc1
    buffer_load_dwordx4 v[140:143], v31, s[16:19], s70 offen offset:1024 sc1
    buffer_load_dwordx4 v[144:147], v31, s[16:19], s69 offen offset:2048 sc1
    buffer_load_dwordx4 v[148:151], v31, s[16:19], s70 offen offset:2048 sc1
    buffer_load_dwordx4 v[152:155], v31, s[16:19], s69 offen offset:3072 sc1
    buffer_load_dwordx4 v[156:159], v31, s[16:19], s70 offen offset:3072 sc1
    s_waitcnt vmcnt(0)
    s_branch .Lk2_ochk3
.Lk2_oretry4:
    s_add_u32 s31, s31, 1
    s_cmp_ge_u32 s31, 262144
    s_cbranch_scc1 .Lk2_ook4
    buffer_load_dwordx4 v[128:131], v31, s[16:19], s69 offen offset:0 sc1
    buffer_load_dwordx4 v[132:135], v31, s[16:19], s70 offen offset:0 sc1
    buffer_load_dwordx4 v[136:139], v31, s[16:19], s69 offen offset:1024 sc1
    buffer_load_dwordx4 v[140:143], v31, s[16:19], s70 offen offset:1024 sc1
    buffer_load_dwordx4 v[144:147], v31, s[16:19], s69 offen offset:2048 sc1
    buffer_load_dwordx4 v[148:151], v31, s[16:19], s70 offen offset:2048 sc1
    buffer_load_dwordx4 v[152:155], v31, s[16:19], s69 offen offset:3072 sc1
    buffer_load_dwordx4 v[156:159], v31, s[16:19], s70 offen offset:3072 sc1
    s_waitcnt vmcnt(0)
    s_branch .Lk2_ochk4
.Lk2_oretry5:
    s_add_u32 s31, s31, 1
    s_cmp_ge_u32 s31, 262144
    s_cbranch_scc1 .Lk2_ook5
    buffer_load_dwordx4 v[136:139], v31, s[16:19], s69 offen offset:1024 sc1
    buffer_load_dwordx4 v[140:143], v31, s[16:19], s70 offen offset:1024 sc1
    buffer_load_dwordx4 v[144:147], v31, s[16:19], s69 offen offset:2048 sc1
    buffer_load_dwordx4 v[148:151], v31, s[16:19], s70 offen offset:2048 sc1
    buffer_load_dwordx4 v[152:155], v31, s[16:19], s69 offen offset:3072 sc1
    buffer_load_dwordx4 v[156:159], v31, s[16:19], s70 offen offset:3072 sc1
    s_waitcnt vmcnt(0)
    s_branch .Lk2_ochk5
.Lk2_oretry6:
    s_add_u32 s31, s31, 1
    s_cmp_ge_u32 s31, 262144
    s_cbranch_scc1 .Lk2_ook6
    buffer_load_dwordx4 v[144:147], v31, s[16:19], s69 offen offset:2048 sc1
    buffer_load_dwordx4 v[148:151], v31, s[16:19], s70 offen offset:2048 sc1
    buffer_load_dwordx4 v[152:155], v31, s[16:19], s69 offen offset:3072 sc1
    buffer_load_dwordx4 v[156:159], v31, s[16:19], s70 offen offset:3072 sc1
    s_waitcnt vmcnt(0)
    s_branch .Lk2_ochk6
.Lk2_oretry7:
    s_add_u32 s31, s31, 1
    s_cmp_ge_u32 s31, 262144
    s_cbranch_scc1 .Lk2_ook7
    buffer_load_dwordx4 v[152:155], v31, s[16:19], s69 offen offset:3072 sc1
    buffer_load_dwordx4 v[156:159], v31, s[16:19], s70 offen offset:3072 sc1
    s_waitcnt vmcnt(0)
    s_branch .Lk2_ochk7
.section .rodata,"a"
.p2align 6
.amdhsa_kernel k2_kernel
  .amdhsa_next_free_vgpr 168
  .amdhsa_next_free_sgpr 102
  .amdhsa_accum_offset 168
  .amdhsa_group_segment_fixed_size 0
  .amdhsa_kernarg_size 80
  .amdhsa_user_sgpr_count 2
  .amdhsa_user_sgpr_kernarg_segment_ptr 1
  .amdhsa_system_sgpr_workgroup_id_x 1
  .amdhsa_float_denorm_mode_32 3
.end_amdhsa_kernel
```
